```python
import torch

def _softmax(x, axis=-1):
    return torch.softmax(x, dim=axis)
def _gelu(x):
    return torch.nn.functional.gelu(x, approximate="tanh")
def _silu(x):
    return torch.nn.functional.silu(x)
def _sigmoid(x):
    return torch.sigmoid(x)
def _layernorm(x, axis=-1, eps=1e-5):
    m = x.mean(dim=axis, keepdim=True)
    v = x.var(dim=axis, keepdim=True, unbiased=False)
    return (x - m) / torch.sqrt(v + eps)
def _scatter_add(tgt, idx, src, axis=0):
    return tgt.clone().index_add_(axis, idx, src)
def _segment_sum(src, seg, n):
    out = torch.zeros((n,) + src.shape[1:], dtype=src.dtype)
    return out.index_add_(0, seg, src)
def _pad(x, pw):
    flat = tuple(v for pair in reversed(pw) for v in pair)
    return torch.nn.functional.pad(x, flat)

kernel_name = 'gated_mix__softmax_full_mha__dense_activation_relu__prompt'

def setup_inputs():

    _w = (lambda a: (lambda t: t.to(torch.bfloat16) if t.is_floating_point() else t)(torch.as_tensor(a)))
    def _A_setup():
        B, S, D = 1, 2048, 512
        return {
            "x": _w((lambda *s: torch.randn(*s, dtype=torch.bfloat16) * 0.05)(B, S, D)),
            "wqkv": _w((lambda *s: torch.randn(*s, dtype=torch.bfloat16) * 0.8)(D, 3 * D)),
            "wo": _w((lambda *s: torch.randn(*s, dtype=torch.bfloat16) * 0.1)(D, D)),
        }
    _A_in = _A_setup()

    def _B_setup():
        B, S, D, Dff = 1, 2048, 512, 1376
        return {
            "x": _w((lambda *s: torch.randn(*s, dtype=torch.bfloat16) * 0.05)(B, S, D)),
            "w1": _w((lambda *s: torch.randn(*s, dtype=torch.bfloat16) * 0.05)(D, Dff)),
            "w2": _w((lambda *s: torch.randn(*s, dtype=torch.bfloat16) * 0.05)(Dff, D)),
        }
    _B_in = _B_setup()

    return {
        "A_x": _A_in["x"],
        "A_wqkv": _A_in["wqkv"],
        "A_wo": _A_in["wo"],
        "B_x": _B_in["x"],
        "B_w1": _B_in["w1"],
        "B_w2": _B_in["w2"],
        "gate_w": _w((lambda *s: torch.randn(*s, dtype=torch.bfloat16) * 0.05)(512) * 16.0),
    }

def reference(A_x, A_wqkv, A_wo, B_x, B_w1, B_w2, gate_w):
    def _A_ref(x, wqkv, wo):
        B, S, D = x.shape
        H = 32; Dh = D // H
        qkv = (lambda x, *d: x.permute(*d))((x @ wqkv).reshape(B, S, 3, H, Dh), 2, 0, 3, 1, 4)
        q, k, v = qkv[0], qkv[1], qkv[2]
        scale = Dh ** -0.5
        scores = torch.einsum("bhqd,bhkd->bhqk", q, k) * scale
        p = _softmax(scores, axis=-1)
        o = torch.einsum("bhqk,bhkd->bhqd", p, v)
        return (lambda x, *d: x.permute(*d))(o, 0, 2, 1, 3).reshape(B, S, D) @ wo

    def _B_ref(x, w1, w2):
        h = torch.einsum("bsd,df->bsf", x, w1)
        zero = torch.zeros_like(h)
        h = torch.maximum(h, zero)
        return torch.einsum("bsf,fd->bsd", h, w2)

    x = A_x
    g = _sigmoid((x * gate_w).sum(-1, keepdims=True))
    a = _A_ref(x, A_wqkv, A_wo)
    b = _B_ref(x, B_w1, B_w2)
    return g * a + (1 - g) * b
```

```asm
; @launch kernel=k1_gemm_kernel grid=(200,1,1) block=(512,1,1) lds=98304
; @launch kernel=k2_attn_kernel grid=(256,1,1) block=(512,1,1) lds=132096
; @launch kernel=k3_out_kernel grid=(256,1,1) block=(256,1,1) lds=131072
.amdgcn_target "amdgcn-amd-amdhsa--gfx950"
.text
.globl k1_gemm_kernel
.p2align 8
.type k1_gemm_kernel,@function
k1_gemm_kernel:
    s_load_dwordx2 s[4:5], s[0:1], 0
    s_load_dwordx2 s[6:7], s[0:1], 8
    s_load_dwordx2 s[8:9], s[0:1], 32
    s_load_dwordx2 s[10:11], s[0:1], 48
    s_load_dwordx2 s[12:13], s[0:1], 72
    s_cmp_ge_u32 s2, 200
    s_cbranch_scc1 K1_DONE
    v_lshrrev_b32 v1, 6, v0
    v_and_b32 v2, 63, v0
    v_readfirstlane_b32 s31, v1
    s_waitcnt lgkmcnt(0)
    s_cmp_ge_u32 s2, 184
    s_cbranch_scc1 K1_G
    s_and_b32 s28, s2, 7
    s_lshr_b32 s29, s2, 3
    s_mov_b32 s16, s4
    s_mov_b32 s17, s5
    s_mov_b32 s18, 0x200000
    s_mov_b32 s19, 0x00020000
    s_cmp_ge_u32 s29, 12
    s_cbranch_scc1 K1_W1
    s_mov_b32 s20, s6
    s_mov_b32 s21, s7
    s_mov_b32 s22, 0x180000
    s_mov_b32 s23, 0x00020000
    s_movk_i32 s30, 3072
    s_lshl_b32 s34, s29, 8
    s_branch K1_WSET
K1_W1:
    s_mov_b32 s20, s8
    s_mov_b32 s21, s9
    s_mov_b32 s22, 0x158000
    s_mov_b32 s23, 0x00020000
    s_movk_i32 s30, 2752
    s_sub_u32 s34, s29, 12
    s_lshl_b32 s34, s34, 8
K1_WSET:
    v_lshrrev_b32 v3, 2, v2
    v_and_b32 v4, 3, v2
    v_lshrrev_b32 v5, 4, v2
    v_xor_b32 v6, v4, v5
    v_lshlrev_b32 v6, 4, v6
    v_lshl_add_u32 v8, v3, 10, v6
    v_and_b32 v4, 15, v2
    v_lshlrev_b32 v6, 2, v5
    v_xor_b32 v4, v4, v6
    v_lshlrev_b32 v4, 4, v4
    v_mul_lo_u32 v6, v5, s30
    v_add_u32 v10, v6, v4
    s_lshl_b32 s32, s31, 11
    s_lshl_b32 s44, s31, 10
    s_lshl_b32 s33, s28, 18
    s_lshl_b32 s35, s31, 15
    s_add_u32 s33, s33, s35
    s_lshl_b32 s35, s31, 2
    s_mul_i32 s35, s35, s30
    s_add_u32 s34, s34, s35
    s_lshr_b32 s36, s31, 1
    s_and_b32 s37, s31, 1
    v_and_b32 v3, 31, v2
    v_lshrrev_b32 v4, 5, v2
    v_lshrrev_b32 v5, 2, v3
    v_and_b32 v5, 3, v5
    s_lshl_b32 s35, s36, 12
    v_lshlrev_b32 v6, 6, v3
    v_add_u32 v6, s35, v6
    v_add_u32 v12, 0, v4
    v_xor_b32 v12, v12, v5
    v_lshl_add_u32 v12, v12, 4, v6
    v_add_u32 v13, 2, v4
    v_xor_b32 v13, v13, v5
    v_lshl_add_u32 v13, v13, 4, v6
    v_lshrrev_b32 v3, 4, v2
    v_and_b32 v4, 1, v3
    v_lshrrev_b32 v3, 1, v3
    v_and_b32 v5, 15, v2
    v_lshrrev_b32 v6, 2, v5
    v_and_b32 v5, 3, v5
    v_lshl_add_u32 v7, v3, 3, v6
    v_lshlrev_b32 v7, 8, v7
    v_lshl_add_u32 v7, v4, 5, v7
    v_lshl_add_u32 v7, v5, 3, v7
    v_add_u32 v7, 0x4000, v7
    s_lshl_b32 s35, s37, 1
    s_add_u32 s35, s35, 0
    v_xor_b32 v11, s35, v6
    v_lshl_add_u32 v16, v11, 6, v7
    s_lshl_b32 s35, s37, 1
    s_add_u32 s35, s35, 1
    v_xor_b32 v11, s35, v6
    v_lshl_add_u32 v17, v11, 6, v7
    v_add_u32 v18, 0xc000, v12
    v_add_u32 v20, 0xc000, v16
    v_add_u32 v19, 0xc000, v13
    v_add_u32 v21, 0xc000, v17
    v_mov_b32 v64, 0
    v_mov_b32 v65, 0
    v_mov_b32 v66, 0
    v_mov_b32 v67, 0
    v_mov_b32 v68, 0
    v_mov_b32 v69, 0
    v_mov_b32 v70, 0
    v_mov_b32 v71, 0
    v_mov_b32 v72, 0
    v_mov_b32 v73, 0
    v_mov_b32 v74, 0
    v_mov_b32 v75, 0
    v_mov_b32 v76, 0
    v_mov_b32 v77, 0
    v_mov_b32 v78, 0
    v_mov_b32 v79, 0
    v_mov_b32 v80, 0
    v_mov_b32 v81, 0
    v_mov_b32 v82, 0
    v_mov_b32 v83, 0
    v_mov_b32 v84, 0
    v_mov_b32 v85, 0
    v_mov_b32 v86, 0
    v_mov_b32 v87, 0
    v_mov_b32 v88, 0
    v_mov_b32 v89, 0
    v_mov_b32 v90, 0
    v_mov_b32 v91, 0
    v_mov_b32 v92, 0
    v_mov_b32 v93, 0
    v_mov_b32 v94, 0
    v_mov_b32 v95, 0
    v_mov_b32 v96, 0
    v_mov_b32 v97, 0
    v_mov_b32 v98, 0
    v_mov_b32 v99, 0
    v_mov_b32 v100, 0
    v_mov_b32 v101, 0
    v_mov_b32 v102, 0
    v_mov_b32 v103, 0
    v_mov_b32 v104, 0
    v_mov_b32 v105, 0
    v_mov_b32 v106, 0
    v_mov_b32 v107, 0
    v_mov_b32 v108, 0
    v_mov_b32 v109, 0
    v_mov_b32 v110, 0
    v_mov_b32 v111, 0
    v_mov_b32 v112, 0
    v_mov_b32 v113, 0
    v_mov_b32 v114, 0
    v_mov_b32 v115, 0
    v_mov_b32 v116, 0
    v_mov_b32 v117, 0
    v_mov_b32 v118, 0
    v_mov_b32 v119, 0
    v_mov_b32 v120, 0
    v_mov_b32 v121, 0
    v_mov_b32 v122, 0
    v_mov_b32 v123, 0
    v_mov_b32 v124, 0
    v_mov_b32 v125, 0
    v_mov_b32 v126, 0
    v_mov_b32 v127, 0
    s_add_u32 m0, s32, 0
    s_add_u32 s35, s33, 0
    buffer_load_dwordx4 v8, s[16:19], s35 offen lds
    s_add_u32 m0, s32, 1024
    s_add_u32 s35, s33, 16384
    buffer_load_dwordx4 v8, s[16:19], s35 offen lds
    s_add_u32 m0, s44, 16384
    s_mul_i32 s35, s30, 0
    s_add_u32 s35, s35, s34
    buffer_load_dwordx4 v10, s[20:23], s35 offen lds
    s_add_u32 m0, s32, 24576
    s_add_u32 s35, s33, 64
    buffer_load_dwordx4 v8, s[16:19], s35 offen lds
    s_add_u32 m0, s32, 25600
    s_add_u32 s35, s33, 16448
    buffer_load_dwordx4 v8, s[16:19], s35 offen lds
    s_add_u32 m0, s44, 40960
    s_mul_i32 s35, s30, 32
    s_add_u32 s35, s35, s34
    buffer_load_dwordx4 v10, s[20:23], s35 offen lds
    s_add_u32 m0, s32, 49152
    s_add_u32 s35, s33, 128
    buffer_load_dwordx4 v8, s[16:19], s35 offen lds
    s_add_u32 m0, s32, 50176
    s_add_u32 s35, s33, 16512
    buffer_load_dwordx4 v8, s[16:19], s35 offen lds
    s_add_u32 m0, s44, 65536
    s_mul_i32 s35, s30, 64
    s_add_u32 s35, s35, s34
    buffer_load_dwordx4 v10, s[20:23], s35 offen lds
    s_cmp_ge_u32 s29, 8
    s_cbranch_scc0 K1_MAIN0
    s_cmp_lt_u32 s29, 12
    s_cbranch_scc1 K1_MAIN1
K1_MAIN0:
    s_waitcnt vmcnt(6)
    s_barrier
    ds_read_b128 v[32:35], v12 offset:0
    ds_read_b128 v[36:39], v12 offset:2048
    ds_read_b64_tr_b16 v[40:41], v16 offset:0
    ds_read_b64_tr_b16 v[42:43], v16 offset:1024
    ds_read_b64_tr_b16 v[44:45], v17 offset:0
    ds_read_b64_tr_b16 v[46:47], v17 offset:1024
    ds_read_b128 v[48:51], v13 offset:0
    ds_read_b128 v[52:55], v13 offset:2048
    ds_read_b64_tr_b16 v[56:57], v16 offset:4096
    ds_read_b64_tr_b16 v[58:59], v16 offset:5120
    ds_read_b64_tr_b16 v[60:61], v17 offset:4096
    ds_read_b64_tr_b16 v[62:63], v17 offset:5120
    s_waitcnt vmcnt(3) lgkmcnt(0)
    s_barrier
    s_add_u32 m0, s32, 73728
    s_add_u32 s35, s33, 192
    buffer_load_dwordx4 v8, s[16:19], s35 offen lds
    s_add_u32 m0, s32, 74752
    s_add_u32 s35, s33, 16576
    buffer_load_dwordx4 v8, s[16:19], s35 offen lds
    s_add_u32 m0, s44, 90112
    s_mul_i32 s35, s30, 96
    s_add_u32 s35, s35, s34
    buffer_load_dwordx4 v10, s[20:23], s35 offen lds
    ds_read_b128 v[128:131], v12 offset:24576
    ds_read_b128 v[132:135], v12 offset:26624
    ds_read_b64_tr_b16 v[136:137], v16 offset:24576
    ds_read_b64_tr_b16 v[138:139], v16 offset:25600
    ds_read_b64_tr_b16 v[140:141], v17 offset:24576
    ds_read_b64_tr_b16 v[142:143], v17 offset:25600
    ds_read_b128 v[144:147], v13 offset:24576
    ds_read_b128 v[148:151], v13 offset:26624
    ds_read_b64_tr_b16 v[152:153], v16 offset:28672
    ds_read_b64_tr_b16 v[154:155], v16 offset:29696
    ds_read_b64_tr_b16 v[156:157], v17 offset:28672
    ds_read_b64_tr_b16 v[158:159], v17 offset:29696
    v_mfma_f32_32x32x16_bf16 v[64:79], v[40:43], v[32:35], v[64:79]
    v_mfma_f32_32x32x16_bf16 v[80:95], v[40:43], v[36:39], v[80:95]
    v_mfma_f32_32x32x16_bf16 v[96:111], v[44:47], v[32:35], v[96:111]
    v_mfma_f32_32x32x16_bf16 v[112:127], v[44:47], v[36:39], v[112:127]
    v_mfma_f32_32x32x16_bf16 v[64:79], v[56:59], v[48:51], v[64:79]
    v_mfma_f32_32x32x16_bf16 v[80:95], v[56:59], v[52:55], v[80:95]
    v_mfma_f32_32x32x16_bf16 v[96:111], v[60:63], v[48:51], v[96:111]
    v_mfma_f32_32x32x16_bf16 v[112:127], v[60:63], v[52:55], v[112:127]
    s_waitcnt vmcnt(3) lgkmcnt(0)
    s_barrier
    s_add_u32 m0, s32, 0
    s_add_u32 s35, s33, 256
    buffer_load_dwordx4 v8, s[16:19], s35 offen lds
    s_add_u32 m0, s32, 1024
    s_add_u32 s35, s33, 16640
    buffer_load_dwordx4 v8, s[16:19], s35 offen lds
    s_add_u32 m0, s44, 16384
    s_mul_i32 s35, s30, 128
    s_add_u32 s35, s35, s34
    buffer_load_dwordx4 v10, s[20:23], s35 offen lds
    ds_read_b128 v[32:35], v18 offset:0
    ds_read_b128 v[36:39], v18 offset:2048
    ds_read_b64_tr_b16 v[40:41], v20 offset:0
    ds_read_b64_tr_b16 v[42:43], v20 offset:1024
    ds_read_b64_tr_b16 v[44:45], v21 offset:0
    ds_read_b64_tr_b16 v[46:47], v21 offset:1024
    ds_read_b128 v[48:51], v19 offset:0
    ds_read_b128 v[52:55], v19 offset:2048
    ds_read_b64_tr_b16 v[56:57], v20 offset:4096
    ds_read_b64_tr_b16 v[58:59], v20 offset:5120
    ds_read_b64_tr_b16 v[60:61], v21 offset:4096
    ds_read_b64_tr_b16 v[62:63], v21 offset:5120
    v_mfma_f32_32x32x16_bf16 v[64:79], v[136:139], v[128:131], v[64:79]
    v_mfma_f32_32x32x16_bf16 v[80:95], v[136:139], v[132:135], v[80:95]
    v_mfma_f32_32x32x16_bf16 v[96:111], v[140:143], v[128:131], v[96:111]
    v_mfma_f32_32x32x16_bf16 v[112:127], v[140:143], v[132:135], v[112:127]
    v_mfma_f32_32x32x16_bf16 v[64:79], v[152:155], v[144:147], v[64:79]
    v_mfma_f32_32x32x16_bf16 v[80:95], v[152:155], v[148:151], v[80:95]
    v_mfma_f32_32x32x16_bf16 v[96:111], v[156:159], v[144:147], v[96:111]
    v_mfma_f32_32x32x16_bf16 v[112:127], v[156:159], v[148:151], v[112:127]
    s_waitcnt vmcnt(3) lgkmcnt(0)
    s_barrier
    s_add_u32 m0, s32, 24576
    s_add_u32 s35, s33, 320
    buffer_load_dwordx4 v8, s[16:19], s35 offen lds
    s_add_u32 m0, s32, 25600
    s_add_u32 s35, s33, 16704
    buffer_load_dwordx4 v8, s[16:19], s35 offen lds
    s_add_u32 m0, s44, 40960
    s_mul_i32 s35, s30, 160
    s_add_u32 s35, s35, s34
    buffer_load_dwordx4 v10, s[20:23], s35 offen lds
    ds_read_b128 v[128:131], v18 offset:24576
    ds_read_b128 v[132:135], v18 offset:26624
    ds_read_b64_tr_b16 v[136:137], v20 offset:24576
    ds_read_b64_tr_b16 v[138:139], v20 offset:25600
    ds_read_b64_tr_b16 v[140:141], v21 offset:24576
    ds_read_b64_tr_b16 v[142:143], v21 offset:25600
    ds_read_b128 v[144:147], v19 offset:24576
    ds_read_b128 v[148:151], v19 offset:26624
    ds_read_b64_tr_b16 v[152:153], v20 offset:28672
    ds_read_b64_tr_b16 v[154:155], v20 offset:29696
    ds_read_b64_tr_b16 v[156:157], v21 offset:28672
    ds_read_b64_tr_b16 v[158:159], v21 offset:29696
    v_mfma_f32_32x32x16_bf16 v[64:79], v[40:43], v[32:35], v[64:79]
    v_mfma_f32_32x32x16_bf16 v[80:95], v[40:43], v[36:39], v[80:95]
    v_mfma_f32_32x32x16_bf16 v[96:111], v[44:47], v[32:35], v[96:111]
    v_mfma_f32_32x32x16_bf16 v[112:127], v[44:47], v[36:39], v[112:127]
    v_mfma_f32_32x32x16_bf16 v[64:79], v[56:59], v[48:51], v[64:79]
    v_mfma_f32_32x32x16_bf16 v[80:95], v[56:59], v[52:55], v[80:95]
    v_mfma_f32_32x32x16_bf16 v[96:111], v[60:63], v[48:51], v[96:111]
    v_mfma_f32_32x32x16_bf16 v[112:127], v[60:63], v[52:55], v[112:127]
    s_waitcnt vmcnt(3) lgkmcnt(0)
    s_barrier
    s_add_u32 m0, s32, 49152
    s_add_u32 s35, s33, 384
    buffer_load_dwordx4 v8, s[16:19], s35 offen lds
    s_add_u32 m0, s32, 50176
    s_add_u32 s35, s33, 16768
    buffer_load_dwordx4 v8, s[16:19], s35 offen lds
    s_add_u32 m0, s44, 65536
    s_mul_i32 s35, s30, 192
    s_add_u32 s35, s35, s34
    buffer_load_dwordx4 v10, s[20:23], s35 offen lds
    ds_read_b128 v[32:35], v12 offset:0
    ds_read_b128 v[36:39], v12 offset:2048
    ds_read_b64_tr_b16 v[40:41], v16 offset:0
    ds_read_b64_tr_b16 v[42:43], v16 offset:1024
    ds_read_b64_tr_b16 v[44:45], v17 offset:0
    ds_read_b64_tr_b16 v[46:47], v17 offset:1024
    ds_read_b128 v[48:51], v13 offset:0
    ds_read_b128 v[52:55], v13 offset:2048
    ds_read_b64_tr_b16 v[56:57], v16 offset:4096
    ds_read_b64_tr_b16 v[58:59], v16 offset:5120
    ds_read_b64_tr_b16 v[60:61], v17 offset:4096
    ds_read_b64_tr_b16 v[62:63], v17 offset:5120
    v_mfma_f32_32x32x16_bf16 v[64:79], v[136:139], v[128:131], v[64:79]
    v_mfma_f32_32x32x16_bf16 v[80:95], v[136:139], v[132:135], v[80:95]
    v_mfma_f32_32x32x16_bf16 v[96:111], v[140:143], v[128:131], v[96:111]
    v_mfma_f32_32x32x16_bf16 v[112:127], v[140:143], v[132:135], v[112:127]
    v_mfma_f32_32x32x16_bf16 v[64:79], v[152:155], v[144:147], v[64:79]
    v_mfma_f32_32x32x16_bf16 v[80:95], v[152:155], v[148:151], v[80:95]
    v_mfma_f32_32x32x16_bf16 v[96:111], v[156:159], v[144:147], v[96:111]
    v_mfma_f32_32x32x16_bf16 v[112:127], v[156:159], v[148:151], v[112:127]
    s_waitcnt vmcnt(3) lgkmcnt(0)
    s_barrier
    s_add_u32 m0, s32, 73728
    s_add_u32 s35, s33, 448
    buffer_load_dwordx4 v8, s[16:19], s35 offen lds
    s_add_u32 m0, s32, 74752
    s_add_u32 s35, s33, 16832
    buffer_load_dwordx4 v8, s[16:19], s35 offen lds
    s_add_u32 m0, s44, 90112
    s_mul_i32 s35, s30, 224
    s_add_u32 s35, s35, s34
    buffer_load_dwordx4 v10, s[20:23], s35 offen lds
    ds_read_b128 v[128:131], v12 offset:24576
    ds_read_b128 v[132:135], v12 offset:26624
    ds_read_b64_tr_b16 v[136:137], v16 offset:24576
    ds_read_b64_tr_b16 v[138:139], v16 offset:25600
    ds_read_b64_tr_b16 v[140:141], v17 offset:24576
    ds_read_b64_tr_b16 v[142:143], v17 offset:25600
    ds_read_b128 v[144:147], v13 offset:24576
    ds_read_b128 v[148:151], v13 offset:26624
    ds_read_b64_tr_b16 v[152:153], v16 offset:28672
    ds_read_b64_tr_b16 v[154:155], v16 offset:29696
    ds_read_b64_tr_b16 v[156:157], v17 offset:28672
    ds_read_b64_tr_b16 v[158:159], v17 offset:29696
    v_mfma_f32_32x32x16_bf16 v[64:79], v[40:43], v[32:35], v[64:79]
    v_mfma_f32_32x32x16_bf16 v[80:95], v[40:43], v[36:39], v[80:95]
    v_mfma_f32_32x32x16_bf16 v[96:111], v[44:47], v[32:35], v[96:111]
    v_mfma_f32_32x32x16_bf16 v[112:127], v[44:47], v[36:39], v[112:127]
    v_mfma_f32_32x32x16_bf16 v[64:79], v[56:59], v[48:51], v[64:79]
    v_mfma_f32_32x32x16_bf16 v[80:95], v[56:59], v[52:55], v[80:95]
    v_mfma_f32_32x32x16_bf16 v[96:111], v[60:63], v[48:51], v[96:111]
    v_mfma_f32_32x32x16_bf16 v[112:127], v[60:63], v[52:55], v[112:127]
    s_waitcnt vmcnt(3) lgkmcnt(0)
    s_barrier
    s_add_u32 m0, s32, 0
    s_add_u32 s35, s33, 512
    buffer_load_dwordx4 v8, s[16:19], s35 offen lds
    s_add_u32 m0, s32, 1024
    s_add_u32 s35, s33, 16896
    buffer_load_dwordx4 v8, s[16:19], s35 offen lds
    s_add_u32 m0, s44, 16384
    s_mul_i32 s35, s30, 256
    s_add_u32 s35, s35, s34
    buffer_load_dwordx4 v10, s[20:23], s35 offen lds
    ds_read_b128 v[32:35], v18 offset:0
    ds_read_b128 v[36:39], v18 offset:2048
    ds_read_b64_tr_b16 v[40:41], v20 offset:0
    ds_read_b64_tr_b16 v[42:43], v20 offset:1024
    ds_read_b64_tr_b16 v[44:45], v21 offset:0
    ds_read_b64_tr_b16 v[46:47], v21 offset:1024
    ds_read_b128 v[48:51], v19 offset:0
    ds_read_b128 v[52:55], v19 offset:2048
    ds_read_b64_tr_b16 v[56:57], v20 offset:4096
    ds_read_b64_tr_b16 v[58:59], v20 offset:5120
    ds_read_b64_tr_b16 v[60:61], v21 offset:4096
    ds_read_b64_tr_b16 v[62:63], v21 offset:5120
    v_mfma_f32_32x32x16_bf16 v[64:79], v[136:139], v[128:131], v[64:79]
    v_mfma_f32_32x32x16_bf16 v[80:95], v[136:139], v[132:135], v[80:95]
    v_mfma_f32_32x32x16_bf16 v[96:111], v[140:143], v[128:131], v[96:111]
    v_mfma_f32_32x32x16_bf16 v[112:127], v[140:143], v[132:135], v[112:127]
    v_mfma_f32_32x32x16_bf16 v[64:79], v[152:155], v[144:147], v[64:79]
    v_mfma_f32_32x32x16_bf16 v[80:95], v[152:155], v[148:151], v[80:95]
    v_mfma_f32_32x32x16_bf16 v[96:111], v[156:159], v[144:147], v[96:111]
    v_mfma_f32_32x32x16_bf16 v[112:127], v[156:159], v[148:151], v[112:127]
    s_waitcnt vmcnt(3) lgkmcnt(0)
    s_barrier
    s_add_u32 m0, s32, 24576
    s_add_u32 s35, s33, 576
    buffer_load_dwordx4 v8, s[16:19], s35 offen lds
    s_add_u32 m0, s32, 25600
    s_add_u32 s35, s33, 16960
    buffer_load_dwordx4 v8, s[16:19], s35 offen lds
    s_add_u32 m0, s44, 40960
    s_mul_i32 s35, s30, 288
    s_add_u32 s35, s35, s34
    buffer_load_dwordx4 v10, s[20:23], s35 offen lds
    ds_read_b128 v[128:131], v18 offset:24576
    ds_read_b128 v[132:135], v18 offset:26624
    ds_read_b64_tr_b16 v[136:137], v20 offset:24576
    ds_read_b64_tr_b16 v[138:139], v20 offset:25600
    ds_read_b64_tr_b16 v[140:141], v21 offset:24576
    ds_read_b64_tr_b16 v[142:143], v21 offset:25600
    ds_read_b128 v[144:147], v19 offset:24576
    ds_read_b128 v[148:151], v19 offset:26624
    ds_read_b64_tr_b16 v[152:153], v20 offset:28672
    ds_read_b64_tr_b16 v[154:155], v20 offset:29696
    ds_read_b64_tr_b16 v[156:157], v21 offset:28672
    ds_read_b64_tr_b16 v[158:159], v21 offset:29696
    v_mfma_f32_32x32x16_bf16 v[64:79], v[40:43], v[32:35], v[64:79]
    v_mfma_f32_32x32x16_bf16 v[80:95], v[40:43], v[36:39], v[80:95]
    v_mfma_f32_32x32x16_bf16 v[96:111], v[44:47], v[32:35], v[96:111]
    v_mfma_f32_32x32x16_bf16 v[112:127], v[44:47], v[36:39], v[112:127]
    v_mfma_f32_32x32x16_bf16 v[64:79], v[56:59], v[48:51], v[64:79]
    v_mfma_f32_32x32x16_bf16 v[80:95], v[56:59], v[52:55], v[80:95]
    v_mfma_f32_32x32x16_bf16 v[96:111], v[60:63], v[48:51], v[96:111]
    v_mfma_f32_32x32x16_bf16 v[112:127], v[60:63], v[52:55], v[112:127]
    s_waitcnt vmcnt(3) lgkmcnt(0)
    s_barrier
    s_add_u32 m0, s32, 49152
    s_add_u32 s35, s33, 640
    buffer_load_dwordx4 v8, s[16:19], s35 offen lds
    s_add_u32 m0, s32, 50176
    s_add_u32 s35, s33, 17024
    buffer_load_dwordx4 v8, s[16:19], s35 offen lds
    s_add_u32 m0, s44, 65536
    s_mul_i32 s35, s30, 320
    s_add_u32 s35, s35, s34
    buffer_load_dwordx4 v10, s[20:23], s35 offen lds
    ds_read_b128 v[32:35], v12 offset:0
    ds_read_b128 v[36:39], v12 offset:2048
    ds_read_b64_tr_b16 v[40:41], v16 offset:0
    ds_read_b64_tr_b16 v[42:43], v16 offset:1024
    ds_read_b64_tr_b16 v[44:45], v17 offset:0
    ds_read_b64_tr_b16 v[46:47], v17 offset:1024
    ds_read_b128 v[48:51], v13 offset:0
    ds_read_b128 v[52:55], v13 offset:2048
    ds_read_b64_tr_b16 v[56:57], v16 offset:4096
    ds_read_b64_tr_b16 v[58:59], v16 offset:5120
    ds_read_b64_tr_b16 v[60:61], v17 offset:4096
    ds_read_b64_tr_b16 v[62:63], v17 offset:5120
    v_mfma_f32_32x32x16_bf16 v[64:79], v[136:139], v[128:131], v[64:79]
    v_mfma_f32_32x32x16_bf16 v[80:95], v[136:139], v[132:135], v[80:95]
    v_mfma_f32_32x32x16_bf16 v[96:111], v[140:143], v[128:131], v[96:111]
    v_mfma_f32_32x32x16_bf16 v[112:127], v[140:143], v[132:135], v[112:127]
    v_mfma_f32_32x32x16_bf16 v[64:79], v[152:155], v[144:147], v[64:79]
    v_mfma_f32_32x32x16_bf16 v[80:95], v[152:155], v[148:151], v[80:95]
    v_mfma_f32_32x32x16_bf16 v[96:111], v[156:159], v[144:147], v[96:111]
    v_mfma_f32_32x32x16_bf16 v[112:127], v[156:159], v[148:151], v[112:127]
    s_waitcnt vmcnt(3) lgkmcnt(0)
    s_barrier
    s_add_u32 m0, s32, 73728
    s_add_u32 s35, s33, 704
    buffer_load_dwordx4 v8, s[16:19], s35 offen lds
    s_add_u32 m0, s32, 74752
    s_add_u32 s35, s33, 17088
    buffer_load_dwordx4 v8, s[16:19], s35 offen lds
    s_add_u32 m0, s44, 90112
    s_mul_i32 s35, s30, 352
    s_add_u32 s35, s35, s34
    buffer_load_dwordx4 v10, s[20:23], s35 offen lds
    ds_read_b128 v[128:131], v12 offset:24576
    ds_read_b128 v[132:135], v12 offset:26624
    ds_read_b64_tr_b16 v[136:137], v16 offset:24576
    ds_read_b64_tr_b16 v[138:139], v16 offset:25600
    ds_read_b64_tr_b16 v[140:141], v17 offset:24576
    ds_read_b64_tr_b16 v[142:143], v17 offset:25600
    ds_read_b128 v[144:147], v13 offset:24576
    ds_read_b128 v[148:151], v13 offset:26624
    ds_read_b64_tr_b16 v[152:153], v16 offset:28672
    ds_read_b64_tr_b16 v[154:155], v16 offset:29696
    ds_read_b64_tr_b16 v[156:157], v17 offset:28672
    ds_read_b64_tr_b16 v[158:159], v17 offset:29696
    v_mfma_f32_32x32x16_bf16 v[64:79], v[40:43], v[32:35], v[64:79]
    v_mfma_f32_32x32x16_bf16 v[80:95], v[40:43], v[36:39], v[80:95]
    v_mfma_f32_32x32x16_bf16 v[96:111], v[44:47], v[32:35], v[96:111]
    v_mfma_f32_32x32x16_bf16 v[112:127], v[44:47], v[36:39], v[112:127]
    v_mfma_f32_32x32x16_bf16 v[64:79], v[56:59], v[48:51], v[64:79]
    v_mfma_f32_32x32x16_bf16 v[80:95], v[56:59], v[52:55], v[80:95]
    v_mfma_f32_32x32x16_bf16 v[96:111], v[60:63], v[48:51], v[96:111]
    v_mfma_f32_32x32x16_bf16 v[112:127], v[60:63], v[52:55], v[112:127]
    s_waitcnt vmcnt(3) lgkmcnt(0)
    s_barrier
    s_add_u32 m0, s32, 0
    s_add_u32 s35, s33, 768
    buffer_load_dwordx4 v8, s[16:19], s35 offen lds
    s_add_u32 m0, s32, 1024
    s_add_u32 s35, s33, 17152
    buffer_load_dwordx4 v8, s[16:19], s35 offen lds
    s_add_u32 m0, s44, 16384
    s_mul_i32 s35, s30, 384
    s_add_u32 s35, s35, s34
    buffer_load_dwordx4 v10, s[20:23], s35 offen lds
    ds_read_b128 v[32:35], v18 offset:0
    ds_read_b128 v[36:39], v18 offset:2048
    ds_read_b64_tr_b16 v[40:41], v20 offset:0
    ds_read_b64_tr_b16 v[42:43], v20 offset:1024
    ds_read_b64_tr_b16 v[44:45], v21 offset:0
    ds_read_b64_tr_b16 v[46:47], v21 offset:1024
    ds_read_b128 v[48:51], v19 offset:0
    ds_read_b128 v[52:55], v19 offset:2048
    ds_read_b64_tr_b16 v[56:57], v20 offset:4096
    ds_read_b64_tr_b16 v[58:59], v20 offset:5120
    ds_read_b64_tr_b16 v[60:61], v21 offset:4096
    ds_read_b64_tr_b16 v[62:63], v21 offset:5120
    v_mfma_f32_32x32x16_bf16 v[64:79], v[136:139], v[128:131], v[64:79]
    v_mfma_f32_32x32x16_bf16 v[80:95], v[136:139], v[132:135], v[80:95]
    v_mfma_f32_32x32x16_bf16 v[96:111], v[140:143], v[128:131], v[96:111]
    v_mfma_f32_32x32x16_bf16 v[112:127], v[140:143], v[132:135], v[112:127]
    v_mfma_f32_32x32x16_bf16 v[64:79], v[152:155], v[144:147], v[64:79]
    v_mfma_f32_32x32x16_bf16 v[80:95], v[152:155], v[148:151], v[80:95]
    v_mfma_f32_32x32x16_bf16 v[96:111], v[156:159], v[144:147], v[96:111]
    v_mfma_f32_32x32x16_bf16 v[112:127], v[156:159], v[148:151], v[112:127]
    s_waitcnt vmcnt(3) lgkmcnt(0)
    s_barrier
    s_add_u32 m0, s32, 24576
    s_add_u32 s35, s33, 832
    buffer_load_dwordx4 v8, s[16:19], s35 offen lds
    s_add_u32 m0, s32, 25600
    s_add_u32 s35, s33, 17216
    buffer_load_dwordx4 v8, s[16:19], s35 offen lds
    s_add_u32 m0, s44, 40960
    s_mul_i32 s35, s30, 416
    s_add_u32 s35, s35, s34
    buffer_load_dwordx4 v10, s[20:23], s35 offen lds
    ds_read_b128 v[128:131], v18 offset:24576
    ds_read_b128 v[132:135], v18 offset:26624
    ds_read_b64_tr_b16 v[136:137], v20 offset:24576
    ds_read_b64_tr_b16 v[138:139], v20 offset:25600
    ds_read_b64_tr_b16 v[140:141], v21 offset:24576
    ds_read_b64_tr_b16 v[142:143], v21 offset:25600
    ds_read_b128 v[144:147], v19 offset:24576
    ds_read_b128 v[148:151], v19 offset:26624
    ds_read_b64_tr_b16 v[152:153], v20 offset:28672
    ds_read_b64_tr_b16 v[154:155], v20 offset:29696
    ds_read_b64_tr_b16 v[156:157], v21 offset:28672
    ds_read_b64_tr_b16 v[158:159], v21 offset:29696
    v_mfma_f32_32x32x16_bf16 v[64:79], v[40:43], v[32:35], v[64:79]
    v_mfma_f32_32x32x16_bf16 v[80:95], v[40:43], v[36:39], v[80:95]
    v_mfma_f32_32x32x16_bf16 v[96:111], v[44:47], v[32:35], v[96:111]
    v_mfma_f32_32x32x16_bf16 v[112:127], v[44:47], v[36:39], v[112:127]
    v_mfma_f32_32x32x16_bf16 v[64:79], v[56:59], v[48:51], v[64:79]
    v_mfma_f32_32x32x16_bf16 v[80:95], v[56:59], v[52:55], v[80:95]
    v_mfma_f32_32x32x16_bf16 v[96:111], v[60:63], v[48:51], v[96:111]
    v_mfma_f32_32x32x16_bf16 v[112:127], v[60:63], v[52:55], v[112:127]
    s_waitcnt vmcnt(3) lgkmcnt(0)
    s_barrier
    s_add_u32 m0, s32, 49152
    s_add_u32 s35, s33, 896
    buffer_load_dwordx4 v8, s[16:19], s35 offen lds
    s_add_u32 m0, s32, 50176
    s_add_u32 s35, s33, 17280
    buffer_load_dwordx4 v8, s[16:19], s35 offen lds
    s_add_u32 m0, s44, 65536
    s_mul_i32 s35, s30, 448
    s_add_u32 s35, s35, s34
    buffer_load_dwordx4 v10, s[20:23], s35 offen lds
    ds_read_b128 v[32:35], v12 offset:0
    ds_read_b128 v[36:39], v12 offset:2048
    ds_read_b64_tr_b16 v[40:41], v16 offset:0
    ds_read_b64_tr_b16 v[42:43], v16 offset:1024
    ds_read_b64_tr_b16 v[44:45], v17 offset:0
    ds_read_b64_tr_b16 v[46:47], v17 offset:1024
    ds_read_b128 v[48:51], v13 offset:0
    ds_read_b128 v[52:55], v13 offset:2048
    ds_read_b64_tr_b16 v[56:57], v16 offset:4096
    ds_read_b64_tr_b16 v[58:59], v16 offset:5120
    ds_read_b64_tr_b16 v[60:61], v17 offset:4096
    ds_read_b64_tr_b16 v[62:63], v17 offset:5120
    v_mfma_f32_32x32x16_bf16 v[64:79], v[136:139], v[128:131], v[64:79]
    v_mfma_f32_32x32x16_bf16 v[80:95], v[136:139], v[132:135], v[80:95]
    v_mfma_f32_32x32x16_bf16 v[96:111], v[140:143], v[128:131], v[96:111]
    v_mfma_f32_32x32x16_bf16 v[112:127], v[140:143], v[132:135], v[112:127]
    v_mfma_f32_32x32x16_bf16 v[64:79], v[152:155], v[144:147], v[64:79]
    v_mfma_f32_32x32x16_bf16 v[80:95], v[152:155], v[148:151], v[80:95]
    v_mfma_f32_32x32x16_bf16 v[96:111], v[156:159], v[144:147], v[96:111]
    v_mfma_f32_32x32x16_bf16 v[112:127], v[156:159], v[148:151], v[112:127]
    s_waitcnt vmcnt(3) lgkmcnt(0)
    s_barrier
    s_add_u32 m0, s32, 73728
    s_add_u32 s35, s33, 960
    buffer_load_dwordx4 v8, s[16:19], s35 offen lds
    s_add_u32 m0, s32, 74752
    s_add_u32 s35, s33, 17344
    buffer_load_dwordx4 v8, s[16:19], s35 offen lds
    s_add_u32 m0, s44, 90112
    s_mul_i32 s35, s30, 480
    s_add_u32 s35, s35, s34
    buffer_load_dwordx4 v10, s[20:23], s35 offen lds
    ds_read_b128 v[128:131], v12 offset:24576
    ds_read_b128 v[132:135], v12 offset:26624
    ds_read_b64_tr_b16 v[136:137], v16 offset:24576
    ds_read_b64_tr_b16 v[138:139], v16 offset:25600
    ds_read_b64_tr_b16 v[140:141], v17 offset:24576
    ds_read_b64_tr_b16 v[142:143], v17 offset:25600
    ds_read_b128 v[144:147], v13 offset:24576
    ds_read_b128 v[148:151], v13 offset:26624
    ds_read_b64_tr_b16 v[152:153], v16 offset:28672
    ds_read_b64_tr_b16 v[154:155], v16 offset:29696
    ds_read_b64_tr_b16 v[156:157], v17 offset:28672
    ds_read_b64_tr_b16 v[158:159], v17 offset:29696
    v_mfma_f32_32x32x16_bf16 v[64:79], v[40:43], v[32:35], v[64:79]
    v_mfma_f32_32x32x16_bf16 v[80:95], v[40:43], v[36:39], v[80:95]
    v_mfma_f32_32x32x16_bf16 v[96:111], v[44:47], v[32:35], v[96:111]
    v_mfma_f32_32x32x16_bf16 v[112:127], v[44:47], v[36:39], v[112:127]
    v_mfma_f32_32x32x16_bf16 v[64:79], v[56:59], v[48:51], v[64:79]
    v_mfma_f32_32x32x16_bf16 v[80:95], v[56:59], v[52:55], v[80:95]
    v_mfma_f32_32x32x16_bf16 v[96:111], v[60:63], v[48:51], v[96:111]
    v_mfma_f32_32x32x16_bf16 v[112:127], v[60:63], v[52:55], v[112:127]
    s_waitcnt vmcnt(3) lgkmcnt(0)
    s_barrier
    ds_read_b128 v[32:35], v18 offset:0
    ds_read_b128 v[36:39], v18 offset:2048
    ds_read_b64_tr_b16 v[40:41], v20 offset:0
    ds_read_b64_tr_b16 v[42:43], v20 offset:1024
    ds_read_b64_tr_b16 v[44:45], v21 offset:0
    ds_read_b64_tr_b16 v[46:47], v21 offset:1024
    ds_read_b128 v[48:51], v19 offset:0
    ds_read_b128 v[52:55], v19 offset:2048
    ds_read_b64_tr_b16 v[56:57], v20 offset:4096
    ds_read_b64_tr_b16 v[58:59], v20 offset:5120
    ds_read_b64_tr_b16 v[60:61], v21 offset:4096
    ds_read_b64_tr_b16 v[62:63], v21 offset:5120
    v_mfma_f32_32x32x16_bf16 v[64:79], v[136:139], v[128:131], v[64:79]
    v_mfma_f32_32x32x16_bf16 v[80:95], v[136:139], v[132:135], v[80:95]
    v_mfma_f32_32x32x16_bf16 v[96:111], v[140:143], v[128:131], v[96:111]
    v_mfma_f32_32x32x16_bf16 v[112:127], v[140:143], v[132:135], v[112:127]
    v_mfma_f32_32x32x16_bf16 v[64:79], v[152:155], v[144:147], v[64:79]
    v_mfma_f32_32x32x16_bf16 v[80:95], v[152:155], v[148:151], v[80:95]
    v_mfma_f32_32x32x16_bf16 v[96:111], v[156:159], v[144:147], v[96:111]
    v_mfma_f32_32x32x16_bf16 v[112:127], v[156:159], v[148:151], v[112:127]
    s_waitcnt vmcnt(0) lgkmcnt(0)
    s_barrier
    ds_read_b128 v[128:131], v18 offset:24576
    ds_read_b128 v[132:135], v18 offset:26624
    ds_read_b64_tr_b16 v[136:137], v20 offset:24576
    ds_read_b64_tr_b16 v[138:139], v20 offset:25600
    ds_read_b64_tr_b16 v[140:141], v21 offset:24576
    ds_read_b64_tr_b16 v[142:143], v21 offset:25600
    ds_read_b128 v[144:147], v19 offset:24576
    ds_read_b128 v[148:151], v19 offset:26624
    ds_read_b64_tr_b16 v[152:153], v20 offset:28672
    ds_read_b64_tr_b16 v[154:155], v20 offset:29696
    ds_read_b64_tr_b16 v[156:157], v21 offset:28672
    ds_read_b64_tr_b16 v[158:159], v21 offset:29696
    v_mfma_f32_32x32x16_bf16 v[64:79], v[40:43], v[32:35], v[64:79]
    v_mfma_f32_32x32x16_bf16 v[80:95], v[40:43], v[36:39], v[80:95]
    v_mfma_f32_32x32x16_bf16 v[96:111], v[44:47], v[32:35], v[96:111]
    v_mfma_f32_32x32x16_bf16 v[112:127], v[44:47], v[36:39], v[112:127]
    v_mfma_f32_32x32x16_bf16 v[64:79], v[56:59], v[48:51], v[64:79]
    v_mfma_f32_32x32x16_bf16 v[80:95], v[56:59], v[52:55], v[80:95]
    v_mfma_f32_32x32x16_bf16 v[96:111], v[60:63], v[48:51], v[96:111]
    v_mfma_f32_32x32x16_bf16 v[112:127], v[60:63], v[52:55], v[112:127]
    s_waitcnt lgkmcnt(0)
    v_mfma_f32_32x32x16_bf16 v[64:79], v[136:139], v[128:131], v[64:79]
    v_mfma_f32_32x32x16_bf16 v[80:95], v[136:139], v[132:135], v[80:95]
    v_mfma_f32_32x32x16_bf16 v[96:111], v[140:143], v[128:131], v[96:111]
    v_mfma_f32_32x32x16_bf16 v[112:127], v[140:143], v[132:135], v[112:127]
    v_mfma_f32_32x32x16_bf16 v[64:79], v[152:155], v[144:147], v[64:79]
    v_mfma_f32_32x32x16_bf16 v[80:95], v[152:155], v[148:151], v[80:95]
    v_mfma_f32_32x32x16_bf16 v[96:111], v[156:159], v[144:147], v[96:111]
    v_mfma_f32_32x32x16_bf16 v[112:127], v[156:159], v[148:151], v[112:127]
    s_nop 15
    s_nop 15
    v_and_b32 v3, 31, v2
    v_lshrrev_b32 v4, 5, v2
    s_lshl_b32 s35, s28, 8
    s_lshl_b32 s38, s36, 6
    s_add_u32 s35, s35, s38
    v_add_u32 v3, s35, v3
    s_cmp_ge_u32 s29, 12
    s_cbranch_scc1 K1_EPI_H
    s_cmp_ge_u32 s29, 4
    s_cbranch_scc1 K1_EPI_K
    s_mov_b32 s24, s12
    s_mov_b32 s25, s13
    s_mov_b32 s26, 0x200000
    s_mov_b32 s27, 0x00020000
    v_lshlrev_b32 v5, 10, v3
    v_lshl_add_u32 v5, v4, 4, v5
    s_lshl_b32 s35, s29, 8
    s_lshl_b32 s38, s37, 7
    s_add_u32 s35, s35, s38
    v_mul_f32 v64, 0x3eb8aa3b, v64
    v_mul_f32 v65, 0x3eb8aa3b, v65
    v_mul_f32 v66, 0x3eb8aa3b, v66
    v_mul_f32 v67, 0x3eb8aa3b, v67
    v_mul_f32 v68, 0x3eb8aa3b, v68
    v_mul_f32 v69, 0x3eb8aa3b, v69
    v_mul_f32 v70, 0x3eb8aa3b, v70
    v_mul_f32 v71, 0x3eb8aa3b, v71
    v_mul_f32 v72, 0x3eb8aa3b, v72
    v_mul_f32 v73, 0x3eb8aa3b, v73
    v_mul_f32 v74, 0x3eb8aa3b, v74
    v_mul_f32 v75, 0x3eb8aa3b, v75
    v_mul_f32 v76, 0x3eb8aa3b, v76
    v_mul_f32 v77, 0x3eb8aa3b, v77
    v_mul_f32 v78, 0x3eb8aa3b, v78
    v_mul_f32 v79, 0x3eb8aa3b, v79
    v_cvt_pk_bf16_f32 v32, v64, v65
    v_cvt_pk_bf16_f32 v33, v66, v67
    v_cvt_pk_bf16_f32 v34, v68, v69
    v_cvt_pk_bf16_f32 v35, v70, v71
    v_cvt_pk_bf16_f32 v36, v72, v73
    v_cvt_pk_bf16_f32 v37, v74, v75
    v_cvt_pk_bf16_f32 v38, v76, v77
    v_cvt_pk_bf16_f32 v39, v78, v79
    s_nop 1
    v_permlane32_swap_b32 v32, v34
    v_permlane32_swap_b32 v33, v35
    v_permlane32_swap_b32 v36, v38
    v_permlane32_swap_b32 v37, v39
    s_add_u32 s38, s35, 0
    buffer_store_dwordx4 v[32:35], v5, s[24:27], s38 offen
    s_add_u32 s38, s35, 32
    buffer_store_dwordx4 v[36:39], v5, s[24:27], s38 offen
    s_nop 1
    v_mul_f32 v80, 0x3eb8aa3b, v80
    v_mul_f32 v81, 0x3eb8aa3b, v81
    v_mul_f32 v82, 0x3eb8aa3b, v82
    v_mul_f32 v83, 0x3eb8aa3b, v83
    v_mul_f32 v84, 0x3eb8aa3b, v84
    v_mul_f32 v85, 0x3eb8aa3b, v85
    v_mul_f32 v86, 0x3eb8aa3b, v86
    v_mul_f32 v87, 0x3eb8aa3b, v87
    v_mul_f32 v88, 0x3eb8aa3b, v88
    v_mul_f32 v89, 0x3eb8aa3b, v89
    v_mul_f32 v90, 0x3eb8aa3b, v90
    v_mul_f32 v91, 0x3eb8aa3b, v91
    v_mul_f32 v92, 0x3eb8aa3b, v92
    v_mul_f32 v93, 0x3eb8aa3b, v93
    v_mul_f32 v94, 0x3eb8aa3b, v94
    v_mul_f32 v95, 0x3eb8aa3b, v95
    v_cvt_pk_bf16_f32 v32, v80, v81
    v_cvt_pk_bf16_f32 v33, v82, v83
    v_cvt_pk_bf16_f32 v34, v84, v85
    v_cvt_pk_bf16_f32 v35, v86, v87
    v_cvt_pk_bf16_f32 v36, v88, v89
    v_cvt_pk_bf16_f32 v37, v90, v91
    v_cvt_pk_bf16_f32 v38, v92, v93
    v_cvt_pk_bf16_f32 v39, v94, v95
    s_nop 1
    v_permlane32_swap_b32 v32, v34
    v_permlane32_swap_b32 v33, v35
    v_permlane32_swap_b32 v36, v38
    v_permlane32_swap_b32 v37, v39
    s_add_u32 s38, s35, 32768
    buffer_store_dwordx4 v[32:35], v5, s[24:27], s38 offen
    s_add_u32 s38, s35, 32800
    buffer_store_dwordx4 v[36:39], v5, s[24:27], s38 offen
    s_nop 1
    v_mul_f32 v96, 0x3eb8aa3b, v96
    v_mul_f32 v97, 0x3eb8aa3b, v97
    v_mul_f32 v98, 0x3eb8aa3b, v98
    v_mul_f32 v99, 0x3eb8aa3b, v99
    v_mul_f32 v100, 0x3eb8aa3b, v100
    v_mul_f32 v101, 0x3eb8aa3b, v101
    v_mul_f32 v102, 0x3eb8aa3b, v102
    v_mul_f32 v103, 0x3eb8aa3b, v103
    v_mul_f32 v104, 0x3eb8aa3b, v104
    v_mul_f32 v105, 0x3eb8aa3b, v105
    v_mul_f32 v106, 0x3eb8aa3b, v106
    v_mul_f32 v107, 0x3eb8aa3b, v107
    v_mul_f32 v108, 0x3eb8aa3b, v108
    v_mul_f32 v109, 0x3eb8aa3b, v109
    v_mul_f32 v110, 0x3eb8aa3b, v110
    v_mul_f32 v111, 0x3eb8aa3b, v111
    v_cvt_pk_bf16_f32 v32, v96, v97
    v_cvt_pk_bf16_f32 v33, v98, v99
    v_cvt_pk_bf16_f32 v34, v100, v101
    v_cvt_pk_bf16_f32 v35, v102, v103
    v_cvt_pk_bf16_f32 v36, v104, v105
    v_cvt_pk_bf16_f32 v37, v106, v107
    v_cvt_pk_bf16_f32 v38, v108, v109
    v_cvt_pk_bf16_f32 v39, v110, v111
    s_nop 1
    v_permlane32_swap_b32 v32, v34
    v_permlane32_swap_b32 v33, v35
    v_permlane32_swap_b32 v36, v38
    v_permlane32_swap_b32 v37, v39
    s_add_u32 s38, s35, 64
    buffer_store_dwordx4 v[32:35], v5, s[24:27], s38 offen
    s_add_u32 s38, s35, 96
    buffer_store_dwordx4 v[36:39], v5, s[24:27], s38 offen
    s_nop 1
    v_mul_f32 v112, 0x3eb8aa3b, v112
    v_mul_f32 v113, 0x3eb8aa3b, v113
    v_mul_f32 v114, 0x3eb8aa3b, v114
    v_mul_f32 v115, 0x3eb8aa3b, v115
    v_mul_f32 v116, 0x3eb8aa3b, v116
    v_mul_f32 v117, 0x3eb8aa3b, v117
    v_mul_f32 v118, 0x3eb8aa3b, v118
    v_mul_f32 v119, 0x3eb8aa3b, v119
    v_mul_f32 v120, 0x3eb8aa3b, v120
    v_mul_f32 v121, 0x3eb8aa3b, v121
    v_mul_f32 v122, 0x3eb8aa3b, v122
    v_mul_f32 v123, 0x3eb8aa3b, v123
    v_mul_f32 v124, 0x3eb8aa3b, v124
    v_mul_f32 v125, 0x3eb8aa3b, v125
    v_mul_f32 v126, 0x3eb8aa3b, v126
    v_mul_f32 v127, 0x3eb8aa3b, v127
    v_cvt_pk_bf16_f32 v32, v112, v113
    v_cvt_pk_bf16_f32 v33, v114, v115
    v_cvt_pk_bf16_f32 v34, v116, v117
    v_cvt_pk_bf16_f32 v35, v118, v119
    v_cvt_pk_bf16_f32 v36, v120, v121
    v_cvt_pk_bf16_f32 v37, v122, v123
    v_cvt_pk_bf16_f32 v38, v124, v125
    v_cvt_pk_bf16_f32 v39, v126, v127
    s_nop 1
    v_permlane32_swap_b32 v32, v34
    v_permlane32_swap_b32 v33, v35
    v_permlane32_swap_b32 v36, v38
    v_permlane32_swap_b32 v37, v39
    s_add_u32 s38, s35, 32832
    buffer_store_dwordx4 v[32:35], v5, s[24:27], s38 offen
    s_add_u32 s38, s35, 32864
    buffer_store_dwordx4 v[36:39], v5, s[24:27], s38 offen
    s_nop 1
    s_branch K1_DONE
K1_EPI_K:
    s_add_u32 s24, s12, 0x200000
    s_addc_u32 s25, s13, 0
    s_mov_b32 s26, 0x200000
    s_mov_b32 s27, 0x00020000
    v_lshlrev_b32 v5, 5, v3
    v_lshl_add_u32 v5, v4, 4, v5
    s_sub_u32 s35, s29, 4
    s_lshl_b32 s35, s35, 19
    s_lshl_b32 s38, s37, 18
    s_add_u32 s35, s35, s38
    v_cvt_pk_bf16_f32 v32, v64, v65
    v_cvt_pk_bf16_f32 v33, v66, v67
    v_cvt_pk_bf16_f32 v34, v68, v69
    v_cvt_pk_bf16_f32 v35, v70, v71
    v_cvt_pk_bf16_f32 v36, v72, v73
    v_cvt_pk_bf16_f32 v37, v74, v75
    v_cvt_pk_bf16_f32 v38, v76, v77
    v_cvt_pk_bf16_f32 v39, v78, v79
    s_nop 1
    v_permlane32_swap_b32 v32, v34
    v_permlane32_swap_b32 v33, v35
    v_permlane32_swap_b32 v36, v38
    v_permlane32_swap_b32 v37, v39
    s_add_u32 s38, s35, 0
    buffer_store_dwordx4 v[32:35], v5, s[24:27], s38 offen
    s_add_u32 s38, s35, 65536
    buffer_store_dwordx4 v[36:39], v5, s[24:27], s38 offen
    s_nop 1
    v_cvt_pk_bf16_f32 v32, v80, v81
    v_cvt_pk_bf16_f32 v33, v82, v83
    v_cvt_pk_bf16_f32 v34, v84, v85
    v_cvt_pk_bf16_f32 v35, v86, v87
    v_cvt_pk_bf16_f32 v36, v88, v89
    v_cvt_pk_bf16_f32 v37, v90, v91
    v_cvt_pk_bf16_f32 v38, v92, v93
    v_cvt_pk_bf16_f32 v39, v94, v95
    s_nop 1
    v_permlane32_swap_b32 v32, v34
    v_permlane32_swap_b32 v33, v35
    v_permlane32_swap_b32 v36, v38
    v_permlane32_swap_b32 v37, v39
    s_add_u32 s38, s35, 1024
    buffer_store_dwordx4 v[32:35], v5, s[24:27], s38 offen
    s_add_u32 s38, s35, 66560
    buffer_store_dwordx4 v[36:39], v5, s[24:27], s38 offen
    s_nop 1
    v_cvt_pk_bf16_f32 v32, v96, v97
    v_cvt_pk_bf16_f32 v33, v98, v99
    v_cvt_pk_bf16_f32 v34, v100, v101
    v_cvt_pk_bf16_f32 v35, v102, v103
    v_cvt_pk_bf16_f32 v36, v104, v105
    v_cvt_pk_bf16_f32 v37, v106, v107
    v_cvt_pk_bf16_f32 v38, v108, v109
    v_cvt_pk_bf16_f32 v39, v110, v111
    s_nop 1
    v_permlane32_swap_b32 v32, v34
    v_permlane32_swap_b32 v33, v35
    v_permlane32_swap_b32 v36, v38
    v_permlane32_swap_b32 v37, v39
    s_add_u32 s38, s35, 131072
    buffer_store_dwordx4 v[32:35], v5, s[24:27], s38 offen
    s_add_u32 s38, s35, 196608
    buffer_store_dwordx4 v[36:39], v5, s[24:27], s38 offen
    s_nop 1
    v_cvt_pk_bf16_f32 v32, v112, v113
    v_cvt_pk_bf16_f32 v33, v114, v115
    v_cvt_pk_bf16_f32 v34, v116, v117
    v_cvt_pk_bf16_f32 v35, v118, v119
    v_cvt_pk_bf16_f32 v36, v120, v121
    v_cvt_pk_bf16_f32 v37, v122, v123
    v_cvt_pk_bf16_f32 v38, v124, v125
    v_cvt_pk_bf16_f32 v39, v126, v127
    s_nop 1
    v_permlane32_swap_b32 v32, v34
    v_permlane32_swap_b32 v33, v35
    v_permlane32_swap_b32 v36, v38
    v_permlane32_swap_b32 v37, v39
    s_add_u32 s38, s35, 132096
    buffer_store_dwordx4 v[32:35], v5, s[24:27], s38 offen
    s_add_u32 s38, s35, 197632
    buffer_store_dwordx4 v[36:39], v5, s[24:27], s38 offen
    s_nop 1
    s_branch K1_DONE
K1_EPI_H:
    s_add_u32 s24, s12, 0x900000
    s_addc_u32 s25, s13, 0
    s_mov_b32 s26, 0x580000
    s_mov_b32 s27, 0x00020000
    s_movk_i32 s38, 2816
    v_mul_lo_u32 v5, v3, s38
    v_lshl_add_u32 v5, v4, 4, v5
    s_sub_u32 s35, s29, 12
    s_lshl_b32 s35, s35, 8
    s_lshl_b32 s38, s37, 7
    s_add_u32 s35, s35, s38
    s_cmp_eq_u32 s29, 22
    s_cselect_b32 s39, 1, 0
    s_cmp_eq_u32 s37, 1
    s_cselect_b32 s40, 1, 0
    s_and_b32 s39, s39, s40
    s_cmp_eq_u32 s39, 1
    s_cbranch_scc0 K1_H_NOZERO
    v_mov_b32 v96, 0
    v_mov_b32 v97, 0
    v_mov_b32 v98, 0
    v_mov_b32 v99, 0
    v_mov_b32 v100, 0
    v_mov_b32 v101, 0
    v_mov_b32 v102, 0
    v_mov_b32 v103, 0
    v_mov_b32 v104, 0
    v_mov_b32 v105, 0
    v_mov_b32 v106, 0
    v_mov_b32 v107, 0
    v_mov_b32 v108, 0
    v_mov_b32 v109, 0
    v_mov_b32 v110, 0
    v_mov_b32 v111, 0
    v_mov_b32 v112, 0
    v_mov_b32 v113, 0
    v_mov_b32 v114, 0
    v_mov_b32 v115, 0
    v_mov_b32 v116, 0
    v_mov_b32 v117, 0
    v_mov_b32 v118, 0
    v_mov_b32 v119, 0
    v_mov_b32 v120, 0
    v_mov_b32 v121, 0
    v_mov_b32 v122, 0
    v_mov_b32 v123, 0
    v_mov_b32 v124, 0
    v_mov_b32 v125, 0
    v_mov_b32 v126, 0
    v_mov_b32 v127, 0
K1_H_NOZERO:
    v_cvt_pk_bf16_f32 v32, v64, v65
    v_cvt_pk_bf16_f32 v33, v66, v67
    v_cvt_pk_bf16_f32 v34, v68, v69
    v_cvt_pk_bf16_f32 v35, v70, v71
    v_cvt_pk_bf16_f32 v36, v72, v73
    v_cvt_pk_bf16_f32 v37, v74, v75
    v_cvt_pk_bf16_f32 v38, v76, v77
    v_cvt_pk_bf16_f32 v39, v78, v79
    v_pk_max_i16 v32, v32, 0
    v_pk_max_i16 v33, v33, 0
    v_pk_max_i16 v34, v34, 0
    v_pk_max_i16 v35, v35, 0
    v_pk_max_i16 v36, v36, 0
    v_pk_max_i16 v37, v37, 0
    v_pk_max_i16 v38, v38, 0
    v_pk_max_i16 v39, v39, 0
    s_nop 1
    v_permlane32_swap_b32 v32, v34
    v_permlane32_swap_b32 v33, v35
    v_permlane32_swap_b32 v36, v38
    v_permlane32_swap_b32 v37, v39
    s_add_u32 s38, s35, 0
    buffer_store_dwordx4 v[32:35], v5, s[24:27], s38 offen
    s_add_u32 s38, s35, 32
    buffer_store_dwordx4 v[36:39], v5, s[24:27], s38 offen
    s_nop 1
    v_cvt_pk_bf16_f32 v32, v80, v81
    v_cvt_pk_bf16_f32 v33, v82, v83
    v_cvt_pk_bf16_f32 v34, v84, v85
    v_cvt_pk_bf16_f32 v35, v86, v87
    v_cvt_pk_bf16_f32 v36, v88, v89
    v_cvt_pk_bf16_f32 v37, v90, v91
    v_cvt_pk_bf16_f32 v38, v92, v93
    v_cvt_pk_bf16_f32 v39, v94, v95
    v_pk_max_i16 v32, v32, 0
    v_pk_max_i16 v33, v33, 0
    v_pk_max_i16 v34, v34, 0
    v_pk_max_i16 v35, v35, 0
    v_pk_max_i16 v36, v36, 0
    v_pk_max_i16 v37, v37, 0
    v_pk_max_i16 v38, v38, 0
    v_pk_max_i16 v39, v39, 0
    s_nop 1
    v_permlane32_swap_b32 v32, v34
    v_permlane32_swap_b32 v33, v35
    v_permlane32_swap_b32 v36, v38
    v_permlane32_swap_b32 v37, v39
    s_add_u32 s38, s35, 90112
    buffer_store_dwordx4 v[32:35], v5, s[24:27], s38 offen
    s_add_u32 s38, s35, 90144
    buffer_store_dwordx4 v[36:39], v5, s[24:27], s38 offen
    s_nop 1
    v_cvt_pk_bf16_f32 v32, v96, v97
    v_cvt_pk_bf16_f32 v33, v98, v99
    v_cvt_pk_bf16_f32 v34, v100, v101
    v_cvt_pk_bf16_f32 v35, v102, v103
    v_cvt_pk_bf16_f32 v36, v104, v105
    v_cvt_pk_bf16_f32 v37, v106, v107
    v_cvt_pk_bf16_f32 v38, v108, v109
    v_cvt_pk_bf16_f32 v39, v110, v111
    v_pk_max_i16 v32, v32, 0
    v_pk_max_i16 v33, v33, 0
    v_pk_max_i16 v34, v34, 0
    v_pk_max_i16 v35, v35, 0
    v_pk_max_i16 v36, v36, 0
    v_pk_max_i16 v37, v37, 0
    v_pk_max_i16 v38, v38, 0
    v_pk_max_i16 v39, v39, 0
    s_nop 1
    v_permlane32_swap_b32 v32, v34
    v_permlane32_swap_b32 v33, v35
    v_permlane32_swap_b32 v36, v38
    v_permlane32_swap_b32 v37, v39
    s_add_u32 s38, s35, 64
    buffer_store_dwordx4 v[32:35], v5, s[24:27], s38 offen
    s_add_u32 s38, s35, 96
    buffer_store_dwordx4 v[36:39], v5, s[24:27], s38 offen
    s_nop 1
    v_cvt_pk_bf16_f32 v32, v112, v113
    v_cvt_pk_bf16_f32 v33, v114, v115
    v_cvt_pk_bf16_f32 v34, v116, v117
    v_cvt_pk_bf16_f32 v35, v118, v119
    v_cvt_pk_bf16_f32 v36, v120, v121
    v_cvt_pk_bf16_f32 v37, v122, v123
    v_cvt_pk_bf16_f32 v38, v124, v125
    v_cvt_pk_bf16_f32 v39, v126, v127
    v_pk_max_i16 v32, v32, 0
    v_pk_max_i16 v33, v33, 0
    v_pk_max_i16 v34, v34, 0
    v_pk_max_i16 v35, v35, 0
    v_pk_max_i16 v36, v36, 0
    v_pk_max_i16 v37, v37, 0
    v_pk_max_i16 v38, v38, 0
    v_pk_max_i16 v39, v39, 0
    s_nop 1
    v_permlane32_swap_b32 v32, v34
    v_permlane32_swap_b32 v33, v35
    v_permlane32_swap_b32 v36, v38
    v_permlane32_swap_b32 v37, v39
    s_add_u32 s38, s35, 90176
    buffer_store_dwordx4 v[32:35], v5, s[24:27], s38 offen
    s_add_u32 s38, s35, 90208
    buffer_store_dwordx4 v[36:39], v5, s[24:27], s38 offen
    s_nop 1
    s_branch K1_DONE
K1_MAIN1:
    s_waitcnt vmcnt(6)
    s_barrier
    ds_read_b128 v[32:35], v12 offset:0
    ds_read_b128 v[36:39], v12 offset:2048
    ds_read_b64_tr_b16 v[40:41], v16 offset:0
    ds_read_b64_tr_b16 v[42:43], v16 offset:1024
    ds_read_b64_tr_b16 v[44:45], v17 offset:0
    ds_read_b64_tr_b16 v[46:47], v17 offset:1024
    ds_read_b128 v[48:51], v13 offset:0
    ds_read_b128 v[52:55], v13 offset:2048
    ds_read_b64_tr_b16 v[56:57], v16 offset:4096
    ds_read_b64_tr_b16 v[58:59], v16 offset:5120
    ds_read_b64_tr_b16 v[60:61], v17 offset:4096
    ds_read_b64_tr_b16 v[62:63], v17 offset:5120
    s_waitcnt vmcnt(3) lgkmcnt(0)
    s_barrier
    s_add_u32 m0, s32, 73728
    s_add_u32 s35, s33, 192
    buffer_load_dwordx4 v8, s[16:19], s35 offen lds
    s_add_u32 m0, s32, 74752
    s_add_u32 s35, s33, 16576
    buffer_load_dwordx4 v8, s[16:19], s35 offen lds
    s_add_u32 m0, s44, 90112
    s_mul_i32 s35, s30, 96
    s_add_u32 s35, s35, s34
    buffer_load_dwordx4 v10, s[20:23], s35 offen lds
    ds_read_b128 v[128:131], v12 offset:24576
    ds_read_b128 v[132:135], v12 offset:26624
    ds_read_b64_tr_b16 v[136:137], v16 offset:24576
    ds_read_b64_tr_b16 v[138:139], v16 offset:25600
    ds_read_b64_tr_b16 v[140:141], v17 offset:24576
    ds_read_b64_tr_b16 v[142:143], v17 offset:25600
    ds_read_b128 v[144:147], v13 offset:24576
    ds_read_b128 v[148:151], v13 offset:26624
    ds_read_b64_tr_b16 v[152:153], v16 offset:28672
    ds_read_b64_tr_b16 v[154:155], v16 offset:29696
    ds_read_b64_tr_b16 v[156:157], v17 offset:28672
    ds_read_b64_tr_b16 v[158:159], v17 offset:29696
    v_mfma_f32_32x32x16_bf16 v[64:79], v[32:35], v[40:43], v[64:79]
    v_mfma_f32_32x32x16_bf16 v[80:95], v[36:39], v[40:43], v[80:95]
    v_mfma_f32_32x32x16_bf16 v[96:111], v[32:35], v[44:47], v[96:111]
    v_mfma_f32_32x32x16_bf16 v[112:127], v[36:39], v[44:47], v[112:127]
    v_mfma_f32_32x32x16_bf16 v[64:79], v[48:51], v[56:59], v[64:79]
    v_mfma_f32_32x32x16_bf16 v[80:95], v[52:55], v[56:59], v[80:95]
    v_mfma_f32_32x32x16_bf16 v[96:111], v[48:51], v[60:63], v[96:111]
    v_mfma_f32_32x32x16_bf16 v[112:127], v[52:55], v[60:63], v[112:127]
    s_waitcnt vmcnt(3) lgkmcnt(0)
    s_barrier
    s_add_u32 m0, s32, 0
    s_add_u32 s35, s33, 256
    buffer_load_dwordx4 v8, s[16:19], s35 offen lds
    s_add_u32 m0, s32, 1024
    s_add_u32 s35, s33, 16640
    buffer_load_dwordx4 v8, s[16:19], s35 offen lds
    s_add_u32 m0, s44, 16384
    s_mul_i32 s35, s30, 128
    s_add_u32 s35, s35, s34
    buffer_load_dwordx4 v10, s[20:23], s35 offen lds
    ds_read_b128 v[32:35], v18 offset:0
    ds_read_b128 v[36:39], v18 offset:2048
    ds_read_b64_tr_b16 v[40:41], v20 offset:0
    ds_read_b64_tr_b16 v[42:43], v20 offset:1024
    ds_read_b64_tr_b16 v[44:45], v21 offset:0
    ds_read_b64_tr_b16 v[46:47], v21 offset:1024
    ds_read_b128 v[48:51], v19 offset:0
    ds_read_b128 v[52:55], v19 offset:2048
    ds_read_b64_tr_b16 v[56:57], v20 offset:4096
    ds_read_b64_tr_b16 v[58:59], v20 offset:5120
    ds_read_b64_tr_b16 v[60:61], v21 offset:4096
    ds_read_b64_tr_b16 v[62:63], v21 offset:5120
    v_mfma_f32_32x32x16_bf16 v[64:79], v[128:131], v[136:139], v[64:79]
    v_mfma_f32_32x32x16_bf16 v[80:95], v[132:135], v[136:139], v[80:95]
    v_mfma_f32_32x32x16_bf16 v[96:111], v[128:131], v[140:143], v[96:111]
    v_mfma_f32_32x32x16_bf16 v[112:127], v[132:135], v[140:143], v[112:127]
    v_mfma_f32_32x32x16_bf16 v[64:79], v[144:147], v[152:155], v[64:79]
    v_mfma_f32_32x32x16_bf16 v[80:95], v[148:151], v[152:155], v[80:95]
    v_mfma_f32_32x32x16_bf16 v[96:111], v[144:147], v[156:159], v[96:111]
    v_mfma_f32_32x32x16_bf16 v[112:127], v[148:151], v[156:159], v[112:127]
    s_waitcnt vmcnt(3) lgkmcnt(0)
    s_barrier
    s_add_u32 m0, s32, 24576
    s_add_u32 s35, s33, 320
    buffer_load_dwordx4 v8, s[16:19], s35 offen lds
    s_add_u32 m0, s32, 25600
    s_add_u32 s35, s33, 16704
    buffer_load_dwordx4 v8, s[16:19], s35 offen lds
    s_add_u32 m0, s44, 40960
    s_mul_i32 s35, s30, 160
    s_add_u32 s35, s35, s34
    buffer_load_dwordx4 v10, s[20:23], s35 offen lds
    ds_read_b128 v[128:131], v18 offset:24576
    ds_read_b128 v[132:135], v18 offset:26624
    ds_read_b64_tr_b16 v[136:137], v20 offset:24576
    ds_read_b64_tr_b16 v[138:139], v20 offset:25600
    ds_read_b64_tr_b16 v[140:141], v21 offset:24576
    ds_read_b64_tr_b16 v[142:143], v21 offset:25600
    ds_read_b128 v[144:147], v19 offset:24576
    ds_read_b128 v[148:151], v19 offset:26624
    ds_read_b64_tr_b16 v[152:153], v20 offset:28672
    ds_read_b64_tr_b16 v[154:155], v20 offset:29696
    ds_read_b64_tr_b16 v[156:157], v21 offset:28672
    ds_read_b64_tr_b16 v[158:159], v21 offset:29696
    v_mfma_f32_32x32x16_bf16 v[64:79], v[32:35], v[40:43], v[64:79]
    v_mfma_f32_32x32x16_bf16 v[80:95], v[36:39], v[40:43], v[80:95]
    v_mfma_f32_32x32x16_bf16 v[96:111], v[32:35], v[44:47], v[96:111]
    v_mfma_f32_32x32x16_bf16 v[112:127], v[36:39], v[44:47], v[112:127]
    v_mfma_f32_32x32x16_bf16 v[64:79], v[48:51], v[56:59], v[64:79]
    v_mfma_f32_32x32x16_bf16 v[80:95], v[52:55], v[56:59], v[80:95]
    v_mfma_f32_32x32x16_bf16 v[96:111], v[48:51], v[60:63], v[96:111]
    v_mfma_f32_32x32x16_bf16 v[112:127], v[52:55], v[60:63], v[112:127]
    s_waitcnt vmcnt(3) lgkmcnt(0)
    s_barrier
    s_add_u32 m0, s32, 49152
    s_add_u32 s35, s33, 384
    buffer_load_dwordx4 v8, s[16:19], s35 offen lds
    s_add_u32 m0, s32, 50176
    s_add_u32 s35, s33, 16768
    buffer_load_dwordx4 v8, s[16:19], s35 offen lds
    s_add_u32 m0, s44, 65536
    s_mul_i32 s35, s30, 192
    s_add_u32 s35, s35, s34
    buffer_load_dwordx4 v10, s[20:23], s35 offen lds
    ds_read_b128 v[32:35], v12 offset:0
    ds_read_b128 v[36:39], v12 offset:2048
    ds_read_b64_tr_b16 v[40:41], v16 offset:0
    ds_read_b64_tr_b16 v[42:43], v16 offset:1024
    ds_read_b64_tr_b16 v[44:45], v17 offset:0
    ds_read_b64_tr_b16 v[46:47], v17 offset:1024
    ds_read_b128 v[48:51], v13 offset:0
    ds_read_b128 v[52:55], v13 offset:2048
    ds_read_b64_tr_b16 v[56:57], v16 offset:4096
    ds_read_b64_tr_b16 v[58:59], v16 offset:5120
    ds_read_b64_tr_b16 v[60:61], v17 offset:4096
    ds_read_b64_tr_b16 v[62:63], v17 offset:5120
    v_mfma_f32_32x32x16_bf16 v[64:79], v[128:131], v[136:139], v[64:79]
    v_mfma_f32_32x32x16_bf16 v[80:95], v[132:135], v[136:139], v[80:95]
    v_mfma_f32_32x32x16_bf16 v[96:111], v[128:131], v[140:143], v[96:111]
    v_mfma_f32_32x32x16_bf16 v[112:127], v[132:135], v[140:143], v[112:127]
    v_mfma_f32_32x32x16_bf16 v[64:79], v[144:147], v[152:155], v[64:79]
    v_mfma_f32_32x32x16_bf16 v[80:95], v[148:151], v[152:155], v[80:95]
    v_mfma_f32_32x32x16_bf16 v[96:111], v[144:147], v[156:159], v[96:111]
    v_mfma_f32_32x32x16_bf16 v[112:127], v[148:151], v[156:159], v[112:127]
    s_waitcnt vmcnt(3) lgkmcnt(0)
    s_barrier
    s_add_u32 m0, s32, 73728
    s_add_u32 s35, s33, 448
    buffer_load_dwordx4 v8, s[16:19], s35 offen lds
    s_add_u32 m0, s32, 74752
    s_add_u32 s35, s33, 16832
    buffer_load_dwordx4 v8, s[16:19], s35 offen lds
    s_add_u32 m0, s44, 90112
    s_mul_i32 s35, s30, 224
    s_add_u32 s35, s35, s34
    buffer_load_dwordx4 v10, s[20:23], s35 offen lds
    ds_read_b128 v[128:131], v12 offset:24576
    ds_read_b128 v[132:135], v12 offset:26624
    ds_read_b64_tr_b16 v[136:137], v16 offset:24576
    ds_read_b64_tr_b16 v[138:139], v16 offset:25600
    ds_read_b64_tr_b16 v[140:141], v17 offset:24576
    ds_read_b64_tr_b16 v[142:143], v17 offset:25600
    ds_read_b128 v[144:147], v13 offset:24576
    ds_read_b128 v[148:151], v13 offset:26624
    ds_read_b64_tr_b16 v[152:153], v16 offset:28672
    ds_read_b64_tr_b16 v[154:155], v16 offset:29696
    ds_read_b64_tr_b16 v[156:157], v17 offset:28672
    ds_read_b64_tr_b16 v[158:159], v17 offset:29696
    v_mfma_f32_32x32x16_bf16 v[64:79], v[32:35], v[40:43], v[64:79]
    v_mfma_f32_32x32x16_bf16 v[80:95], v[36:39], v[40:43], v[80:95]
    v_mfma_f32_32x32x16_bf16 v[96:111], v[32:35], v[44:47], v[96:111]
    v_mfma_f32_32x32x16_bf16 v[112:127], v[36:39], v[44:47], v[112:127]
    v_mfma_f32_32x32x16_bf16 v[64:79], v[48:51], v[56:59], v[64:79]
    v_mfma_f32_32x32x16_bf16 v[80:95], v[52:55], v[56:59], v[80:95]
    v_mfma_f32_32x32x16_bf16 v[96:111], v[48:51], v[60:63], v[96:111]
    v_mfma_f32_32x32x16_bf16 v[112:127], v[52:55], v[60:63], v[112:127]
    s_waitcnt vmcnt(3) lgkmcnt(0)
    s_barrier
    s_add_u32 m0, s32, 0
    s_add_u32 s35, s33, 512
    buffer_load_dwordx4 v8, s[16:19], s35 offen lds
    s_add_u32 m0, s32, 1024
    s_add_u32 s35, s33, 16896
    buffer_load_dwordx4 v8, s[16:19], s35 offen lds
    s_add_u32 m0, s44, 16384
    s_mul_i32 s35, s30, 256
    s_add_u32 s35, s35, s34
    buffer_load_dwordx4 v10, s[20:23], s35 offen lds
    ds_read_b128 v[32:35], v18 offset:0
    ds_read_b128 v[36:39], v18 offset:2048
    ds_read_b64_tr_b16 v[40:41], v20 offset:0
    ds_read_b64_tr_b16 v[42:43], v20 offset:1024
    ds_read_b64_tr_b16 v[44:45], v21 offset:0
    ds_read_b64_tr_b16 v[46:47], v21 offset:1024
    ds_read_b128 v[48:51], v19 offset:0
    ds_read_b128 v[52:55], v19 offset:2048
    ds_read_b64_tr_b16 v[56:57], v20 offset:4096
    ds_read_b64_tr_b16 v[58:59], v20 offset:5120
    ds_read_b64_tr_b16 v[60:61], v21 offset:4096
    ds_read_b64_tr_b16 v[62:63], v21 offset:5120
    v_mfma_f32_32x32x16_bf16 v[64:79], v[128:131], v[136:139], v[64:79]
    v_mfma_f32_32x32x16_bf16 v[80:95], v[132:135], v[136:139], v[80:95]
    v_mfma_f32_32x32x16_bf16 v[96:111], v[128:131], v[140:143], v[96:111]
    v_mfma_f32_32x32x16_bf16 v[112:127], v[132:135], v[140:143], v[112:127]
    v_mfma_f32_32x32x16_bf16 v[64:79], v[144:147], v[152:155], v[64:79]
    v_mfma_f32_32x32x16_bf16 v[80:95], v[148:151], v[152:155], v[80:95]
    v_mfma_f32_32x32x16_bf16 v[96:111], v[144:147], v[156:159], v[96:111]
    v_mfma_f32_32x32x16_bf16 v[112:127], v[148:151], v[156:159], v[112:127]
    s_waitcnt vmcnt(3) lgkmcnt(0)
    s_barrier
    s_add_u32 m0, s32, 24576
    s_add_u32 s35, s33, 576
    buffer_load_dwordx4 v8, s[16:19], s35 offen lds
    s_add_u32 m0, s32, 25600
    s_add_u32 s35, s33, 16960
    buffer_load_dwordx4 v8, s[16:19], s35 offen lds
    s_add_u32 m0, s44, 40960
    s_mul_i32 s35, s30, 288
    s_add_u32 s35, s35, s34
    buffer_load_dwordx4 v10, s[20:23], s35 offen lds
    ds_read_b128 v[128:131], v18 offset:24576
    ds_read_b128 v[132:135], v18 offset:26624
    ds_read_b64_tr_b16 v[136:137], v20 offset:24576
    ds_read_b64_tr_b16 v[138:139], v20 offset:25600
    ds_read_b64_tr_b16 v[140:141], v21 offset:24576
    ds_read_b64_tr_b16 v[142:143], v21 offset:25600
    ds_read_b128 v[144:147], v19 offset:24576
    ds_read_b128 v[148:151], v19 offset:26624
    ds_read_b64_tr_b16 v[152:153], v20 offset:28672
    ds_read_b64_tr_b16 v[154:155], v20 offset:29696
    ds_read_b64_tr_b16 v[156:157], v21 offset:28672
    ds_read_b64_tr_b16 v[158:159], v21 offset:29696
    v_mfma_f32_32x32x16_bf16 v[64:79], v[32:35], v[40:43], v[64:79]
    v_mfma_f32_32x32x16_bf16 v[80:95], v[36:39], v[40:43], v[80:95]
    v_mfma_f32_32x32x16_bf16 v[96:111], v[32:35], v[44:47], v[96:111]
    v_mfma_f32_32x32x16_bf16 v[112:127], v[36:39], v[44:47], v[112:127]
    v_mfma_f32_32x32x16_bf16 v[64:79], v[48:51], v[56:59], v[64:79]
    v_mfma_f32_32x32x16_bf16 v[80:95], v[52:55], v[56:59], v[80:95]
    v_mfma_f32_32x32x16_bf16 v[96:111], v[48:51], v[60:63], v[96:111]
    v_mfma_f32_32x32x16_bf16 v[112:127], v[52:55], v[60:63], v[112:127]
    s_waitcnt vmcnt(3) lgkmcnt(0)
    s_barrier
    s_add_u32 m0, s32, 49152
    s_add_u32 s35, s33, 640
    buffer_load_dwordx4 v8, s[16:19], s35 offen lds
    s_add_u32 m0, s32, 50176
    s_add_u32 s35, s33, 17024
    buffer_load_dwordx4 v8, s[16:19], s35 offen lds
    s_add_u32 m0, s44, 65536
    s_mul_i32 s35, s30, 320
    s_add_u32 s35, s35, s34
    buffer_load_dwordx4 v10, s[20:23], s35 offen lds
    ds_read_b128 v[32:35], v12 offset:0
    ds_read_b128 v[36:39], v12 offset:2048
    ds_read_b64_tr_b16 v[40:41], v16 offset:0
    ds_read_b64_tr_b16 v[42:43], v16 offset:1024
    ds_read_b64_tr_b16 v[44:45], v17 offset:0
    ds_read_b64_tr_b16 v[46:47], v17 offset:1024
    ds_read_b128 v[48:51], v13 offset:0
    ds_read_b128 v[52:55], v13 offset:2048
    ds_read_b64_tr_b16 v[56:57], v16 offset:4096
    ds_read_b64_tr_b16 v[58:59], v16 offset:5120
    ds_read_b64_tr_b16 v[60:61], v17 offset:4096
    ds_read_b64_tr_b16 v[62:63], v17 offset:5120
    v_mfma_f32_32x32x16_bf16 v[64:79], v[128:131], v[136:139], v[64:79]
    v_mfma_f32_32x32x16_bf16 v[80:95], v[132:135], v[136:139], v[80:95]
    v_mfma_f32_32x32x16_bf16 v[96:111], v[128:131], v[140:143], v[96:111]
    v_mfma_f32_32x32x16_bf16 v[112:127], v[132:135], v[140:143], v[112:127]
    v_mfma_f32_32x32x16_bf16 v[64:79], v[144:147], v[152:155], v[64:79]
    v_mfma_f32_32x32x16_bf16 v[80:95], v[148:151], v[152:155], v[80:95]
    v_mfma_f32_32x32x16_bf16 v[96:111], v[144:147], v[156:159], v[96:111]
    v_mfma_f32_32x32x16_bf16 v[112:127], v[148:151], v[156:159], v[112:127]
    s_waitcnt vmcnt(3) lgkmcnt(0)
    s_barrier
    s_add_u32 m0, s32, 73728
    s_add_u32 s35, s33, 704
    buffer_load_dwordx4 v8, s[16:19], s35 offen lds
    s_add_u32 m0, s32, 74752
    s_add_u32 s35, s33, 17088
    buffer_load_dwordx4 v8, s[16:19], s35 offen lds
    s_add_u32 m0, s44, 90112
    s_mul_i32 s35, s30, 352
    s_add_u32 s35, s35, s34
    buffer_load_dwordx4 v10, s[20:23], s35 offen lds
    ds_read_b128 v[128:131], v12 offset:24576
    ds_read_b128 v[132:135], v12 offset:26624
    ds_read_b64_tr_b16 v[136:137], v16 offset:24576
    ds_read_b64_tr_b16 v[138:139], v16 offset:25600
    ds_read_b64_tr_b16 v[140:141], v17 offset:24576
    ds_read_b64_tr_b16 v[142:143], v17 offset:25600
    ds_read_b128 v[144:147], v13 offset:24576
    ds_read_b128 v[148:151], v13 offset:26624
    ds_read_b64_tr_b16 v[152:153], v16 offset:28672
    ds_read_b64_tr_b16 v[154:155], v16 offset:29696
    ds_read_b64_tr_b16 v[156:157], v17 offset:28672
    ds_read_b64_tr_b16 v[158:159], v17 offset:29696
    v_mfma_f32_32x32x16_bf16 v[64:79], v[32:35], v[40:43], v[64:79]
    v_mfma_f32_32x32x16_bf16 v[80:95], v[36:39], v[40:43], v[80:95]
    v_mfma_f32_32x32x16_bf16 v[96:111], v[32:35], v[44:47], v[96:111]
    v_mfma_f32_32x32x16_bf16 v[112:127], v[36:39], v[44:47], v[112:127]
    v_mfma_f32_32x32x16_bf16 v[64:79], v[48:51], v[56:59], v[64:79]
    v_mfma_f32_32x32x16_bf16 v[80:95], v[52:55], v[56:59], v[80:95]
    v_mfma_f32_32x32x16_bf16 v[96:111], v[48:51], v[60:63], v[96:111]
    v_mfma_f32_32x32x16_bf16 v[112:127], v[52:55], v[60:63], v[112:127]
    s_waitcnt vmcnt(3) lgkmcnt(0)
    s_barrier
    s_add_u32 m0, s32, 0
    s_add_u32 s35, s33, 768
    buffer_load_dwordx4 v8, s[16:19], s35 offen lds
    s_add_u32 m0, s32, 1024
    s_add_u32 s35, s33, 17152
    buffer_load_dwordx4 v8, s[16:19], s35 offen lds
    s_add_u32 m0, s44, 16384
    s_mul_i32 s35, s30, 384
    s_add_u32 s35, s35, s34
    buffer_load_dwordx4 v10, s[20:23], s35 offen lds
    ds_read_b128 v[32:35], v18 offset:0
    ds_read_b128 v[36:39], v18 offset:2048
    ds_read_b64_tr_b16 v[40:41], v20 offset:0
    ds_read_b64_tr_b16 v[42:43], v20 offset:1024
    ds_read_b64_tr_b16 v[44:45], v21 offset:0
    ds_read_b64_tr_b16 v[46:47], v21 offset:1024
    ds_read_b128 v[48:51], v19 offset:0
    ds_read_b128 v[52:55], v19 offset:2048
    ds_read_b64_tr_b16 v[56:57], v20 offset:4096
    ds_read_b64_tr_b16 v[58:59], v20 offset:5120
    ds_read_b64_tr_b16 v[60:61], v21 offset:4096
    ds_read_b64_tr_b16 v[62:63], v21 offset:5120
    v_mfma_f32_32x32x16_bf16 v[64:79], v[128:131], v[136:139], v[64:79]
    v_mfma_f32_32x32x16_bf16 v[80:95], v[132:135], v[136:139], v[80:95]
    v_mfma_f32_32x32x16_bf16 v[96:111], v[128:131], v[140:143], v[96:111]
    v_mfma_f32_32x32x16_bf16 v[112:127], v[132:135], v[140:143], v[112:127]
    v_mfma_f32_32x32x16_bf16 v[64:79], v[144:147], v[152:155], v[64:79]
    v_mfma_f32_32x32x16_bf16 v[80:95], v[148:151], v[152:155], v[80:95]
    v_mfma_f32_32x32x16_bf16 v[96:111], v[144:147], v[156:159], v[96:111]
    v_mfma_f32_32x32x16_bf16 v[112:127], v[148:151], v[156:159], v[112:127]
    s_waitcnt vmcnt(3) lgkmcnt(0)
    s_barrier
    s_add_u32 m0, s32, 24576
    s_add_u32 s35, s33, 832
    buffer_load_dwordx4 v8, s[16:19], s35 offen lds
    s_add_u32 m0, s32, 25600
    s_add_u32 s35, s33, 17216
    buffer_load_dwordx4 v8, s[16:19], s35 offen lds
    s_add_u32 m0, s44, 40960
    s_mul_i32 s35, s30, 416
    s_add_u32 s35, s35, s34
    buffer_load_dwordx4 v10, s[20:23], s35 offen lds
    ds_read_b128 v[128:131], v18 offset:24576
    ds_read_b128 v[132:135], v18 offset:26624
    ds_read_b64_tr_b16 v[136:137], v20 offset:24576
    ds_read_b64_tr_b16 v[138:139], v20 offset:25600
    ds_read_b64_tr_b16 v[140:141], v21 offset:24576
    ds_read_b64_tr_b16 v[142:143], v21 offset:25600
    ds_read_b128 v[144:147], v19 offset:24576
    ds_read_b128 v[148:151], v19 offset:26624
    ds_read_b64_tr_b16 v[152:153], v20 offset:28672
    ds_read_b64_tr_b16 v[154:155], v20 offset:29696
    ds_read_b64_tr_b16 v[156:157], v21 offset:28672
    ds_read_b64_tr_b16 v[158:159], v21 offset:29696
    v_mfma_f32_32x32x16_bf16 v[64:79], v[32:35], v[40:43], v[64:79]
    v_mfma_f32_32x32x16_bf16 v[80:95], v[36:39], v[40:43], v[80:95]
    v_mfma_f32_32x32x16_bf16 v[96:111], v[32:35], v[44:47], v[96:111]
    v_mfma_f32_32x32x16_bf16 v[112:127], v[36:39], v[44:47], v[112:127]
    v_mfma_f32_32x32x16_bf16 v[64:79], v[48:51], v[56:59], v[64:79]
    v_mfma_f32_32x32x16_bf16 v[80:95], v[52:55], v[56:59], v[80:95]
    v_mfma_f32_32x32x16_bf16 v[96:111], v[48:51], v[60:63], v[96:111]
    v_mfma_f32_32x32x16_bf16 v[112:127], v[52:55], v[60:63], v[112:127]
    s_waitcnt vmcnt(3) lgkmcnt(0)
    s_barrier
    s_add_u32 m0, s32, 49152
    s_add_u32 s35, s33, 896
    buffer_load_dwordx4 v8, s[16:19], s35 offen lds
    s_add_u32 m0, s32, 50176
    s_add_u32 s35, s33, 17280
    buffer_load_dwordx4 v8, s[16:19], s35 offen lds
    s_add_u32 m0, s44, 65536
    s_mul_i32 s35, s30, 448
    s_add_u32 s35, s35, s34
    buffer_load_dwordx4 v10, s[20:23], s35 offen lds
    ds_read_b128 v[32:35], v12 offset:0
    ds_read_b128 v[36:39], v12 offset:2048
    ds_read_b64_tr_b16 v[40:41], v16 offset:0
    ds_read_b64_tr_b16 v[42:43], v16 offset:1024
    ds_read_b64_tr_b16 v[44:45], v17 offset:0
    ds_read_b64_tr_b16 v[46:47], v17 offset:1024
    ds_read_b128 v[48:51], v13 offset:0
    ds_read_b128 v[52:55], v13 offset:2048
    ds_read_b64_tr_b16 v[56:57], v16 offset:4096
    ds_read_b64_tr_b16 v[58:59], v16 offset:5120
    ds_read_b64_tr_b16 v[60:61], v17 offset:4096
    ds_read_b64_tr_b16 v[62:63], v17 offset:5120
    v_mfma_f32_32x32x16_bf16 v[64:79], v[128:131], v[136:139], v[64:79]
    v_mfma_f32_32x32x16_bf16 v[80:95], v[132:135], v[136:139], v[80:95]
    v_mfma_f32_32x32x16_bf16 v[96:111], v[128:131], v[140:143], v[96:111]
    v_mfma_f32_32x32x16_bf16 v[112:127], v[132:135], v[140:143], v[112:127]
    v_mfma_f32_32x32x16_bf16 v[64:79], v[144:147], v[152:155], v[64:79]
    v_mfma_f32_32x32x16_bf16 v[80:95], v[148:151], v[152:155], v[80:95]
    v_mfma_f32_32x32x16_bf16 v[96:111], v[144:147], v[156:159], v[96:111]
    v_mfma_f32_32x32x16_bf16 v[112:127], v[148:151], v[156:159], v[112:127]
    s_waitcnt vmcnt(3) lgkmcnt(0)
    s_barrier
    s_add_u32 m0, s32, 73728
    s_add_u32 s35, s33, 960
    buffer_load_dwordx4 v8, s[16:19], s35 offen lds
    s_add_u32 m0, s32, 74752
    s_add_u32 s35, s33, 17344
    buffer_load_dwordx4 v8, s[16:19], s35 offen lds
    s_add_u32 m0, s44, 90112
    s_mul_i32 s35, s30, 480
    s_add_u32 s35, s35, s34
    buffer_load_dwordx4 v10, s[20:23], s35 offen lds
    ds_read_b128 v[128:131], v12 offset:24576
    ds_read_b128 v[132:135], v12 offset:26624
    ds_read_b64_tr_b16 v[136:137], v16 offset:24576
    ds_read_b64_tr_b16 v[138:139], v16 offset:25600
    ds_read_b64_tr_b16 v[140:141], v17 offset:24576
    ds_read_b64_tr_b16 v[142:143], v17 offset:25600
    ds_read_b128 v[144:147], v13 offset:24576
    ds_read_b128 v[148:151], v13 offset:26624
    ds_read_b64_tr_b16 v[152:153], v16 offset:28672
    ds_read_b64_tr_b16 v[154:155], v16 offset:29696
    ds_read_b64_tr_b16 v[156:157], v17 offset:28672
    ds_read_b64_tr_b16 v[158:159], v17 offset:29696
    v_mfma_f32_32x32x16_bf16 v[64:79], v[32:35], v[40:43], v[64:79]
    v_mfma_f32_32x32x16_bf16 v[80:95], v[36:39], v[40:43], v[80:95]
    v_mfma_f32_32x32x16_bf16 v[96:111], v[32:35], v[44:47], v[96:111]
    v_mfma_f32_32x32x16_bf16 v[112:127], v[36:39], v[44:47], v[112:127]
    v_mfma_f32_32x32x16_bf16 v[64:79], v[48:51], v[56:59], v[64:79]
    v_mfma_f32_32x32x16_bf16 v[80:95], v[52:55], v[56:59], v[80:95]
    v_mfma_f32_32x32x16_bf16 v[96:111], v[48:51], v[60:63], v[96:111]
    v_mfma_f32_32x32x16_bf16 v[112:127], v[52:55], v[60:63], v[112:127]
    s_waitcnt vmcnt(3) lgkmcnt(0)
    s_barrier
    ds_read_b128 v[32:35], v18 offset:0
    ds_read_b128 v[36:39], v18 offset:2048
    ds_read_b64_tr_b16 v[40:41], v20 offset:0
    ds_read_b64_tr_b16 v[42:43], v20 offset:1024
    ds_read_b64_tr_b16 v[44:45], v21 offset:0
    ds_read_b64_tr_b16 v[46:47], v21 offset:1024
    ds_read_b128 v[48:51], v19 offset:0
    ds_read_b128 v[52:55], v19 offset:2048
    ds_read_b64_tr_b16 v[56:57], v20 offset:4096
    ds_read_b64_tr_b16 v[58:59], v20 offset:5120
    ds_read_b64_tr_b16 v[60:61], v21 offset:4096
    ds_read_b64_tr_b16 v[62:63], v21 offset:5120
    v_mfma_f32_32x32x16_bf16 v[64:79], v[128:131], v[136:139], v[64:79]
    v_mfma_f32_32x32x16_bf16 v[80:95], v[132:135], v[136:139], v[80:95]
    v_mfma_f32_32x32x16_bf16 v[96:111], v[128:131], v[140:143], v[96:111]
    v_mfma_f32_32x32x16_bf16 v[112:127], v[132:135], v[140:143], v[112:127]
    v_mfma_f32_32x32x16_bf16 v[64:79], v[144:147], v[152:155], v[64:79]
    v_mfma_f32_32x32x16_bf16 v[80:95], v[148:151], v[152:155], v[80:95]
    v_mfma_f32_32x32x16_bf16 v[96:111], v[144:147], v[156:159], v[96:111]
    v_mfma_f32_32x32x16_bf16 v[112:127], v[148:151], v[156:159], v[112:127]
    s_waitcnt vmcnt(0) lgkmcnt(0)
    s_barrier
    ds_read_b128 v[128:131], v18 offset:24576
    ds_read_b128 v[132:135], v18 offset:26624
    ds_read_b64_tr_b16 v[136:137], v20 offset:24576
    ds_read_b64_tr_b16 v[138:139], v20 offset:25600
    ds_read_b64_tr_b16 v[140:141], v21 offset:24576
    ds_read_b64_tr_b16 v[142:143], v21 offset:25600
    ds_read_b128 v[144:147], v19 offset:24576
    ds_read_b128 v[148:151], v19 offset:26624
    ds_read_b64_tr_b16 v[152:153], v20 offset:28672
    ds_read_b64_tr_b16 v[154:155], v20 offset:29696
    ds_read_b64_tr_b16 v[156:157], v21 offset:28672
    ds_read_b64_tr_b16 v[158:159], v21 offset:29696
    v_mfma_f32_32x32x16_bf16 v[64:79], v[32:35], v[40:43], v[64:79]
    v_mfma_f32_32x32x16_bf16 v[80:95], v[36:39], v[40:43], v[80:95]
    v_mfma_f32_32x32x16_bf16 v[96:111], v[32:35], v[44:47], v[96:111]
    v_mfma_f32_32x32x16_bf16 v[112:127], v[36:39], v[44:47], v[112:127]
    v_mfma_f32_32x32x16_bf16 v[64:79], v[48:51], v[56:59], v[64:79]
    v_mfma_f32_32x32x16_bf16 v[80:95], v[52:55], v[56:59], v[80:95]
    v_mfma_f32_32x32x16_bf16 v[96:111], v[48:51], v[60:63], v[96:111]
    v_mfma_f32_32x32x16_bf16 v[112:127], v[52:55], v[60:63], v[112:127]
    s_waitcnt lgkmcnt(0)
    v_mfma_f32_32x32x16_bf16 v[64:79], v[128:131], v[136:139], v[64:79]
    v_mfma_f32_32x32x16_bf16 v[80:95], v[132:135], v[136:139], v[80:95]
    v_mfma_f32_32x32x16_bf16 v[96:111], v[128:131], v[140:143], v[96:111]
    v_mfma_f32_32x32x16_bf16 v[112:127], v[132:135], v[140:143], v[112:127]
    v_mfma_f32_32x32x16_bf16 v[64:79], v[144:147], v[152:155], v[64:79]
    v_mfma_f32_32x32x16_bf16 v[80:95], v[148:151], v[152:155], v[80:95]
    v_mfma_f32_32x32x16_bf16 v[96:111], v[144:147], v[156:159], v[96:111]
    v_mfma_f32_32x32x16_bf16 v[112:127], v[148:151], v[156:159], v[112:127]
    s_nop 15
    s_nop 15
    s_add_u32 s24, s12, 0x400000
    s_addc_u32 s25, s13, 0
    s_mov_b32 s26, 0x200000
    s_mov_b32 s27, 0x00020000
    v_and_b32 v3, 15, v2
    v_lshrrev_b32 v4, 5, v2
    v_lshrrev_b32 v5, 4, v2
    v_and_b32 v5, 1, v5
    v_lshl_add_u32 v3, v4, 4, v3
    v_lshlrev_b32 v3, 4, v3
    v_lshl_add_u32 v5, v5, 16, v3
    s_sub_u32 s35, s29, 8
    s_lshl_b32 s35, s35, 19
    s_lshl_b32 s38, s37, 18
    s_add_u32 s35, s35, s38
    s_lshl_b32 s38, s28, 13
    s_add_u32 s35, s35, s38
    s_lshl_b32 s38, s36, 11
    s_add_u32 s35, s35, s38
    v_cvt_pk_bf16_f32 v32, v64, v65
    v_cvt_pk_bf16_f32 v33, v66, v67
    v_cvt_pk_bf16_f32 v34, v68, v69
    v_cvt_pk_bf16_f32 v35, v70, v71
    v_cvt_pk_bf16_f32 v36, v72, v73
    v_cvt_pk_bf16_f32 v37, v74, v75
    v_cvt_pk_bf16_f32 v38, v76, v77
    v_cvt_pk_bf16_f32 v39, v78, v79
    s_add_u32 s38, s35, 0
    buffer_store_dwordx4 v[32:35], v5, s[24:27], s38 offen
    s_add_u32 s38, s35, 512
    buffer_store_dwordx4 v[36:39], v5, s[24:27], s38 offen
    s_nop 1
    v_cvt_pk_bf16_f32 v32, v80, v81
    v_cvt_pk_bf16_f32 v33, v82, v83
    v_cvt_pk_bf16_f32 v34, v84, v85
    v_cvt_pk_bf16_f32 v35, v86, v87
    v_cvt_pk_bf16_f32 v36, v88, v89
    v_cvt_pk_bf16_f32 v37, v90, v91
    v_cvt_pk_bf16_f32 v38, v92, v93
    v_cvt_pk_bf16_f32 v39, v94, v95
    s_add_u32 s38, s35, 1024
    buffer_store_dwordx4 v[32:35], v5, s[24:27], s38 offen
    s_add_u32 s38, s35, 1536
    buffer_store_dwordx4 v[36:39], v5, s[24:27], s38 offen
    s_nop 1
    v_cvt_pk_bf16_f32 v32, v96, v97
    v_cvt_pk_bf16_f32 v33, v98, v99
    v_cvt_pk_bf16_f32 v34, v100, v101
    v_cvt_pk_bf16_f32 v35, v102, v103
    v_cvt_pk_bf16_f32 v36, v104, v105
    v_cvt_pk_bf16_f32 v37, v106, v107
    v_cvt_pk_bf16_f32 v38, v108, v109
    v_cvt_pk_bf16_f32 v39, v110, v111
    s_add_u32 s38, s35, 131072
    buffer_store_dwordx4 v[32:35], v5, s[24:27], s38 offen
    s_add_u32 s38, s35, 131584
    buffer_store_dwordx4 v[36:39], v5, s[24:27], s38 offen
    s_nop 1
    v_cvt_pk_bf16_f32 v32, v112, v113
    v_cvt_pk_bf16_f32 v33, v114, v115
    v_cvt_pk_bf16_f32 v34, v116, v117
    v_cvt_pk_bf16_f32 v35, v118, v119
    v_cvt_pk_bf16_f32 v36, v120, v121
    v_cvt_pk_bf16_f32 v37, v122, v123
    v_cvt_pk_bf16_f32 v38, v124, v125
    v_cvt_pk_bf16_f32 v39, v126, v127
    s_add_u32 s38, s35, 132096
    buffer_store_dwordx4 v[32:35], v5, s[24:27], s38 offen
    s_add_u32 s38, s35, 132608
    buffer_store_dwordx4 v[36:39], v5, s[24:27], s38 offen
    s_nop 1
    s_branch K1_DONE
K1_G:
    s_mov_b32 s16, s4
    s_mov_b32 s17, s5
    s_mov_b32 s18, 0x200000
    s_mov_b32 s19, 0x00020000
    s_mov_b32 s20, s10
    s_mov_b32 s21, s11
    s_mov_b32 s22, 0x400
    s_mov_b32 s23, 0x00020000
    s_add_u32 s24, s12, 0x800000
    s_addc_u32 s25, s13, 0
    s_mov_b32 s26, 0x2000
    s_mov_b32 s27, 0x00020000
    s_sub_u32 s28, s2, 184
    s_lshl_b32 s28, s28, 7
    s_lshl_b32 s35, s31, 4
    s_add_u32 s28, s28, s35
    v_and_b32 v3, 15, v2
    v_lshrrev_b32 v4, 4, v2
    v_lshlrev_b32 v5, 6, v3
    buffer_load_dwordx4 v[8:11], v5, s[20:23], 0 offen offset:0
    buffer_load_dwordx4 v[12:15], v5, s[20:23], 0 offen offset:16
    buffer_load_dwordx4 v[16:19], v5, s[20:23], 0 offen offset:32
    buffer_load_dwordx4 v[20:23], v5, s[20:23], 0 offen offset:48
    v_lshl_add_u32 v6, v4, 10, v5
    s_lshl_b32 s35, s28, 10
    s_waitcnt vmcnt(0)
    v_lshlrev_b32 v32, 16, v8
    v_and_b32 v33, 0xffff0000, v8
    v_lshlrev_b32 v34, 16, v9
    v_and_b32 v35, 0xffff0000, v9
    v_lshlrev_b32 v36, 16, v10
    v_and_b32 v37, 0xffff0000, v10
    v_lshlrev_b32 v38, 16, v11
    v_and_b32 v39, 0xffff0000, v11
    v_lshlrev_b32 v40, 16, v12
    v_and_b32 v41, 0xffff0000, v12
    v_lshlrev_b32 v42, 16, v13
    v_and_b32 v43, 0xffff0000, v13
    v_lshlrev_b32 v44, 16, v14
    v_and_b32 v45, 0xffff0000, v14
    v_lshlrev_b32 v46, 16, v15
    v_and_b32 v47, 0xffff0000, v15
    v_lshlrev_b32 v48, 16, v16
    v_and_b32 v49, 0xffff0000, v16
    v_lshlrev_b32 v50, 16, v17
    v_and_b32 v51, 0xffff0000, v17
    v_lshlrev_b32 v52, 16, v18
    v_and_b32 v53, 0xffff0000, v18
    v_lshlrev_b32 v54, 16, v19
    v_and_b32 v55, 0xffff0000, v19
    v_lshlrev_b32 v56, 16, v20
    v_and_b32 v57, 0xffff0000, v20
    v_lshlrev_b32 v58, 16, v21
    v_and_b32 v59, 0xffff0000, v21
    v_lshlrev_b32 v60, 16, v22
    v_and_b32 v61, 0xffff0000, v22
    v_lshlrev_b32 v62, 16, v23
    v_and_b32 v63, 0xffff0000, v23
    buffer_load_dwordx4 v[8:11], v6, s[16:19], s35 offen offset:0
    buffer_load_dwordx4 v[12:15], v6, s[16:19], s35 offen offset:16
    buffer_load_dwordx4 v[16:19], v6, s[16:19], s35 offen offset:32
    buffer_load_dwordx4 v[20:23], v6, s[16:19], s35 offen offset:48
    v_mov_b32 v24, 0
    s_waitcnt vmcnt(0)
    v_lshlrev_b32 v25, 16, v8
    v_and_b32 v26, 0xffff0000, v8
    v_fmac_f32 v24, v25, v32
    v_fmac_f32 v24, v26, v33
    v_lshlrev_b32 v25, 16, v9
    v_and_b32 v26, 0xffff0000, v9
    v_fmac_f32 v24, v25, v34
    v_fmac_f32 v24, v26, v35
    v_lshlrev_b32 v25, 16, v10
    v_and_b32 v26, 0xffff0000, v10
    v_fmac_f32 v24, v25, v36
    v_fmac_f32 v24, v26, v37
    v_lshlrev_b32 v25, 16, v11
    v_and_b32 v26, 0xffff0000, v11
    v_fmac_f32 v24, v25, v38
    v_fmac_f32 v24, v26, v39
    v_lshlrev_b32 v25, 16, v12
    v_and_b32 v26, 0xffff0000, v12
    v_fmac_f32 v24, v25, v40
    v_fmac_f32 v24, v26, v41
    v_lshlrev_b32 v25, 16, v13
    v_and_b32 v26, 0xffff0000, v13
    v_fmac_f32 v24, v25, v42
    v_fmac_f32 v24, v26, v43
    v_lshlrev_b32 v25, 16, v14
    v_and_b32 v26, 0xffff0000, v14
    v_fmac_f32 v24, v25, v44
    v_fmac_f32 v24, v26, v45
    v_lshlrev_b32 v25, 16, v15
    v_and_b32 v26, 0xffff0000, v15
    v_fmac_f32 v24, v25, v46
    v_fmac_f32 v24, v26, v47
    v_lshlrev_b32 v25, 16, v16
    v_and_b32 v26, 0xffff0000, v16
    v_fmac_f32 v24, v25, v48
    v_fmac_f32 v24, v26, v49
    v_lshlrev_b32 v25, 16, v17
    v_and_b32 v26, 0xffff0000, v17
    v_fmac_f32 v24, v25, v50
    v_fmac_f32 v24, v26, v51
    v_lshlrev_b32 v25, 16, v18
    v_and_b32 v26, 0xffff0000, v18
    v_fmac_f32 v24, v25, v52
    v_fmac_f32 v24, v26, v53
    v_lshlrev_b32 v25, 16, v19
    v_and_b32 v26, 0xffff0000, v19
    v_fmac_f32 v24, v25, v54
    v_fmac_f32 v24, v26, v55
    v_lshlrev_b32 v25, 16, v20
    v_and_b32 v26, 0xffff0000, v20
    v_fmac_f32 v24, v25, v56
    v_fmac_f32 v24, v26, v57
    v_lshlrev_b32 v25, 16, v21
    v_and_b32 v26, 0xffff0000, v21
    v_fmac_f32 v24, v25, v58
    v_fmac_f32 v24, v26, v59
    v_lshlrev_b32 v25, 16, v22
    v_and_b32 v26, 0xffff0000, v22
    v_fmac_f32 v24, v25, v60
    v_fmac_f32 v24, v26, v61
    v_lshlrev_b32 v25, 16, v23
    v_and_b32 v26, 0xffff0000, v23
    v_fmac_f32 v24, v25, v62
    v_fmac_f32 v24, v26, v63
    s_nop 1
    v_add_f32_dpp v24, v24, v24 row_ror:8 row_mask:0xf bank_mask:0xf
    s_nop 1
    v_add_f32_dpp v24, v24, v24 row_ror:4 row_mask:0xf bank_mask:0xf
    s_nop 1
    v_add_f32_dpp v24, v24, v24 row_ror:2 row_mask:0xf bank_mask:0xf
    s_nop 1
    v_add_f32_dpp v24, v24, v24 row_ror:1 row_mask:0xf bank_mask:0xf
    v_mul_f32 v24, 0xbfb8aa3b, v24
    v_exp_f32 v24, v24
    s_nop 0
    v_add_f32 v24, 1.0, v24
    v_rcp_f32 v24, v24
    v_lshlrev_b32 v25, 2, v4
    s_lshl_b32 s38, s28, 2
    s_add_u32 s38, s38, 0
    buffer_store_dword v24, v25, s[24:27], s38 offen
    s_add_u32 s35, s35, 4096
    buffer_load_dwordx4 v[8:11], v6, s[16:19], s35 offen offset:0
    buffer_load_dwordx4 v[12:15], v6, s[16:19], s35 offen offset:16
    buffer_load_dwordx4 v[16:19], v6, s[16:19], s35 offen offset:32
    buffer_load_dwordx4 v[20:23], v6, s[16:19], s35 offen offset:48
    v_mov_b32 v24, 0
    s_waitcnt vmcnt(0)
    v_lshlrev_b32 v25, 16, v8
    v_and_b32 v26, 0xffff0000, v8
    v_fmac_f32 v24, v25, v32
    v_fmac_f32 v24, v26, v33
    v_lshlrev_b32 v25, 16, v9
    v_and_b32 v26, 0xffff0000, v9
    v_fmac_f32 v24, v25, v34
    v_fmac_f32 v24, v26, v35
    v_lshlrev_b32 v25, 16, v10
    v_and_b32 v26, 0xffff0000, v10
    v_fmac_f32 v24, v25, v36
    v_fmac_f32 v24, v26, v37
    v_lshlrev_b32 v25, 16, v11
    v_and_b32 v26, 0xffff0000, v11
    v_fmac_f32 v24, v25, v38
    v_fmac_f32 v24, v26, v39
    v_lshlrev_b32 v25, 16, v12
    v_and_b32 v26, 0xffff0000, v12
    v_fmac_f32 v24, v25, v40
    v_fmac_f32 v24, v26, v41
    v_lshlrev_b32 v25, 16, v13
    v_and_b32 v26, 0xffff0000, v13
    v_fmac_f32 v24, v25, v42
    v_fmac_f32 v24, v26, v43
    v_lshlrev_b32 v25, 16, v14
    v_and_b32 v26, 0xffff0000, v14
    v_fmac_f32 v24, v25, v44
    v_fmac_f32 v24, v26, v45
    v_lshlrev_b32 v25, 16, v15
    v_and_b32 v26, 0xffff0000, v15
    v_fmac_f32 v24, v25, v46
    v_fmac_f32 v24, v26, v47
    v_lshlrev_b32 v25, 16, v16
    v_and_b32 v26, 0xffff0000, v16
    v_fmac_f32 v24, v25, v48
    v_fmac_f32 v24, v26, v49
    v_lshlrev_b32 v25, 16, v17
    v_and_b32 v26, 0xffff0000, v17
    v_fmac_f32 v24, v25, v50
    v_fmac_f32 v24, v26, v51
    v_lshlrev_b32 v25, 16, v18
    v_and_b32 v26, 0xffff0000, v18
    v_fmac_f32 v24, v25, v52
    v_fmac_f32 v24, v26, v53
    v_lshlrev_b32 v25, 16, v19
    v_and_b32 v26, 0xffff0000, v19
    v_fmac_f32 v24, v25, v54
    v_fmac_f32 v24, v26, v55
    v_lshlrev_b32 v25, 16, v20
    v_and_b32 v26, 0xffff0000, v20
    v_fmac_f32 v24, v25, v56
    v_fmac_f32 v24, v26, v57
    v_lshlrev_b32 v25, 16, v21
    v_and_b32 v26, 0xffff0000, v21
    v_fmac_f32 v24, v25, v58
    v_fmac_f32 v24, v26, v59
    v_lshlrev_b32 v25, 16, v22
    v_and_b32 v26, 0xffff0000, v22
    v_fmac_f32 v24, v25, v60
    v_fmac_f32 v24, v26, v61
    v_lshlrev_b32 v25, 16, v23
    v_and_b32 v26, 0xffff0000, v23
    v_fmac_f32 v24, v25, v62
    v_fmac_f32 v24, v26, v63
    s_nop 1
    v_add_f32_dpp v24, v24, v24 row_ror:8 row_mask:0xf bank_mask:0xf
    s_nop 1
    v_add_f32_dpp v24, v24, v24 row_ror:4 row_mask:0xf bank_mask:0xf
    s_nop 1
    v_add_f32_dpp v24, v24, v24 row_ror:2 row_mask:0xf bank_mask:0xf
    s_nop 1
    v_add_f32_dpp v24, v24, v24 row_ror:1 row_mask:0xf bank_mask:0xf
    v_mul_f32 v24, 0xbfb8aa3b, v24
    v_exp_f32 v24, v24
    s_nop 0
    v_add_f32 v24, 1.0, v24
    v_rcp_f32 v24, v24
    v_lshlrev_b32 v25, 2, v4
    s_lshl_b32 s38, s28, 2
    s_add_u32 s38, s38, 16
    buffer_store_dword v24, v25, s[24:27], s38 offen
    s_add_u32 s35, s35, 4096
    buffer_load_dwordx4 v[8:11], v6, s[16:19], s35 offen offset:0
    buffer_load_dwordx4 v[12:15], v6, s[16:19], s35 offen offset:16
    buffer_load_dwordx4 v[16:19], v6, s[16:19], s35 offen offset:32
    buffer_load_dwordx4 v[20:23], v6, s[16:19], s35 offen offset:48
    v_mov_b32 v24, 0
    s_waitcnt vmcnt(0)
    v_lshlrev_b32 v25, 16, v8
    v_and_b32 v26, 0xffff0000, v8
    v_fmac_f32 v24, v25, v32
    v_fmac_f32 v24, v26, v33
    v_lshlrev_b32 v25, 16, v9
    v_and_b32 v26, 0xffff0000, v9
    v_fmac_f32 v24, v25, v34
    v_fmac_f32 v24, v26, v35
    v_lshlrev_b32 v25, 16, v10
    v_and_b32 v26, 0xffff0000, v10
    v_fmac_f32 v24, v25, v36
    v_fmac_f32 v24, v26, v37
    v_lshlrev_b32 v25, 16, v11
    v_and_b32 v26, 0xffff0000, v11
    v_fmac_f32 v24, v25, v38
    v_fmac_f32 v24, v26, v39
    v_lshlrev_b32 v25, 16, v12
    v_and_b32 v26, 0xffff0000, v12
    v_fmac_f32 v24, v25, v40
    v_fmac_f32 v24, v26, v41
    v_lshlrev_b32 v25, 16, v13
    v_and_b32 v26, 0xffff0000, v13
    v_fmac_f32 v24, v25, v42
    v_fmac_f32 v24, v26, v43
    v_lshlrev_b32 v25, 16, v14
    v_and_b32 v26, 0xffff0000, v14
    v_fmac_f32 v24, v25, v44
    v_fmac_f32 v24, v26, v45
    v_lshlrev_b32 v25, 16, v15
    v_and_b32 v26, 0xffff0000, v15
    v_fmac_f32 v24, v25, v46
    v_fmac_f32 v24, v26, v47
    v_lshlrev_b32 v25, 16, v16
    v_and_b32 v26, 0xffff0000, v16
    v_fmac_f32 v24, v25, v48
    v_fmac_f32 v24, v26, v49
    v_lshlrev_b32 v25, 16, v17
    v_and_b32 v26, 0xffff0000, v17
    v_fmac_f32 v24, v25, v50
    v_fmac_f32 v24, v26, v51
    v_lshlrev_b32 v25, 16, v18
    v_and_b32 v26, 0xffff0000, v18
    v_fmac_f32 v24, v25, v52
    v_fmac_f32 v24, v26, v53
    v_lshlrev_b32 v25, 16, v19
    v_and_b32 v26, 0xffff0000, v19
    v_fmac_f32 v24, v25, v54
    v_fmac_f32 v24, v26, v55
    v_lshlrev_b32 v25, 16, v20
    v_and_b32 v26, 0xffff0000, v20
    v_fmac_f32 v24, v25, v56
    v_fmac_f32 v24, v26, v57
    v_lshlrev_b32 v25, 16, v21
    v_and_b32 v26, 0xffff0000, v21
    v_fmac_f32 v24, v25, v58
    v_fmac_f32 v24, v26, v59
    v_lshlrev_b32 v25, 16, v22
    v_and_b32 v26, 0xffff0000, v22
    v_fmac_f32 v24, v25, v60
    v_fmac_f32 v24, v26, v61
    v_lshlrev_b32 v25, 16, v23
    v_and_b32 v26, 0xffff0000, v23
    v_fmac_f32 v24, v25, v62
    v_fmac_f32 v24, v26, v63
    s_nop 1
    v_add_f32_dpp v24, v24, v24 row_ror:8 row_mask:0xf bank_mask:0xf
    s_nop 1
    v_add_f32_dpp v24, v24, v24 row_ror:4 row_mask:0xf bank_mask:0xf
    s_nop 1
    v_add_f32_dpp v24, v24, v24 row_ror:2 row_mask:0xf bank_mask:0xf
    s_nop 1
    v_add_f32_dpp v24, v24, v24 row_ror:1 row_mask:0xf bank_mask:0xf
    v_mul_f32 v24, 0xbfb8aa3b, v24
    v_exp_f32 v24, v24
    s_nop 0
    v_add_f32 v24, 1.0, v24
    v_rcp_f32 v24, v24
    v_lshlrev_b32 v25, 2, v4
    s_lshl_b32 s38, s28, 2
    s_add_u32 s38, s38, 32
    buffer_store_dword v24, v25, s[24:27], s38 offen
    s_add_u32 s35, s35, 4096
    buffer_load_dwordx4 v[8:11], v6, s[16:19], s35 offen offset:0
    buffer_load_dwordx4 v[12:15], v6, s[16:19], s35 offen offset:16
    buffer_load_dwordx4 v[16:19], v6, s[16:19], s35 offen offset:32
    buffer_load_dwordx4 v[20:23], v6, s[16:19], s35 offen offset:48
    v_mov_b32 v24, 0
    s_waitcnt vmcnt(0)
    v_lshlrev_b32 v25, 16, v8
    v_and_b32 v26, 0xffff0000, v8
    v_fmac_f32 v24, v25, v32
    v_fmac_f32 v24, v26, v33
    v_lshlrev_b32 v25, 16, v9
    v_and_b32 v26, 0xffff0000, v9
    v_fmac_f32 v24, v25, v34
    v_fmac_f32 v24, v26, v35
    v_lshlrev_b32 v25, 16, v10
    v_and_b32 v26, 0xffff0000, v10
    v_fmac_f32 v24, v25, v36
    v_fmac_f32 v24, v26, v37
    v_lshlrev_b32 v25, 16, v11
    v_and_b32 v26, 0xffff0000, v11
    v_fmac_f32 v24, v25, v38
    v_fmac_f32 v24, v26, v39
    v_lshlrev_b32 v25, 16, v12
    v_and_b32 v26, 0xffff0000, v12
    v_fmac_f32 v24, v25, v40
    v_fmac_f32 v24, v26, v41
    v_lshlrev_b32 v25, 16, v13
    v_and_b32 v26, 0xffff0000, v13
    v_fmac_f32 v24, v25, v42
    v_fmac_f32 v24, v26, v43
    v_lshlrev_b32 v25, 16, v14
    v_and_b32 v26, 0xffff0000, v14
    v_fmac_f32 v24, v25, v44
    v_fmac_f32 v24, v26, v45
    v_lshlrev_b32 v25, 16, v15
    v_and_b32 v26, 0xffff0000, v15
    v_fmac_f32 v24, v25, v46
    v_fmac_f32 v24, v26, v47
    v_lshlrev_b32 v25, 16, v16
    v_and_b32 v26, 0xffff0000, v16
    v_fmac_f32 v24, v25, v48
    v_fmac_f32 v24, v26, v49
    v_lshlrev_b32 v25, 16, v17
    v_and_b32 v26, 0xffff0000, v17
    v_fmac_f32 v24, v25, v50
    v_fmac_f32 v24, v26, v51
    v_lshlrev_b32 v25, 16, v18
    v_and_b32 v26, 0xffff0000, v18
    v_fmac_f32 v24, v25, v52
    v_fmac_f32 v24, v26, v53
    v_lshlrev_b32 v25, 16, v19
    v_and_b32 v26, 0xffff0000, v19
    v_fmac_f32 v24, v25, v54
    v_fmac_f32 v24, v26, v55
    v_lshlrev_b32 v25, 16, v20
    v_and_b32 v26, 0xffff0000, v20
    v_fmac_f32 v24, v25, v56
    v_fmac_f32 v24, v26, v57
    v_lshlrev_b32 v25, 16, v21
    v_and_b32 v26, 0xffff0000, v21
    v_fmac_f32 v24, v25, v58
    v_fmac_f32 v24, v26, v59
    v_lshlrev_b32 v25, 16, v22
    v_and_b32 v26, 0xffff0000, v22
    v_fmac_f32 v24, v25, v60
    v_fmac_f32 v24, v26, v61
    v_lshlrev_b32 v25, 16, v23
    v_and_b32 v26, 0xffff0000, v23
    v_fmac_f32 v24, v25, v62
    v_fmac_f32 v24, v26, v63
    s_nop 1
    v_add_f32_dpp v24, v24, v24 row_ror:8 row_mask:0xf bank_mask:0xf
    s_nop 1
    v_add_f32_dpp v24, v24, v24 row_ror:4 row_mask:0xf bank_mask:0xf
    s_nop 1
    v_add_f32_dpp v24, v24, v24 row_ror:2 row_mask:0xf bank_mask:0xf
    s_nop 1
    v_add_f32_dpp v24, v24, v24 row_ror:1 row_mask:0xf bank_mask:0xf
    v_mul_f32 v24, 0xbfb8aa3b, v24
    v_exp_f32 v24, v24
    s_nop 0
    v_add_f32 v24, 1.0, v24
    v_rcp_f32 v24, v24
    v_lshlrev_b32 v25, 2, v4
    s_lshl_b32 s38, s28, 2
    s_add_u32 s38, s38, 48
    buffer_store_dword v24, v25, s[24:27], s38 offen
    s_add_u32 s35, s35, 4096
K1_DONE:
    s_endpgm
.globl k2_attn_kernel
.p2align 8
.type k2_attn_kernel,@function
k2_attn_kernel:
    s_load_dwordx2 s[12:13], s[0:1], 72
    s_cmp_ge_u32 s2, 256
    s_cbranch_scc1 K2_DONE
    v_lshrrev_b32 v1, 6, v0
    v_and_b32 v2, 63, v0
    v_readfirstlane_b32 s31, v1
    s_and_b32 s28, s2, 7
    s_lshl_b32 s28, s28, 2
    s_lshr_b32 s29, s2, 3
    s_and_b32 s29, s29, 3
    s_add_u32 s28, s28, s29
    s_lshr_b32 s29, s2, 5
    s_waitcnt lgkmcnt(0)
    s_lshl_b32 s35, s28, 16
    s_add_u32 s16, s12, s35
    s_addc_u32 s17, s13, 0
    s_add_u32 s20, s16, 0x400000
    s_addc_u32 s21, s17, 0
    s_add_u32 s16, s16, 0x200000
    s_addc_u32 s17, s17, 0
    s_mov_b32 s18, 0x10000
    s_mov_b32 s19, 0x00020000
    s_mov_b32 s22, 0x10000
    s_mov_b32 s23, 0x00020000
    s_mov_b32 s24, s12
    s_mov_b32 s25, s13
    s_mov_b32 s26, 0x200000
    s_mov_b32 s27, 0x00020000
    v_and_b32 v3, 31, v2
    v_lshrrev_b32 v4, 5, v2
    s_lshl_b32 s35, s29, 8
    s_lshl_b32 s36, s31, 5
    s_add_u32 s35, s35, s36
    v_add_u32 v3, s35, v3
    v_lshlrev_b32 v5, 10, v3
    v_lshl_add_u32 v5, v4, 4, v5
    s_lshl_b32 s36, s28, 5
    buffer_load_dwordx4 v[8:11], v5, s[24:27], s36 offen
    v_lshlrev_b32 v6, 4, v2
    s_lshl_b32 s32, s31, 10
    s_add_u32 m0, s32, 0
    s_add_u32 s36, s32, 0
    buffer_load_dwordx4 v6, s[16:19], s36 offen lds
    s_add_u32 m0, s32, 65536
    buffer_load_dwordx4 v6, s[20:23], s36 offen lds
    s_add_u32 m0, s32, 8192
    s_add_u32 s36, s32, 8192
    buffer_load_dwordx4 v6, s[16:19], s36 offen lds
    s_add_u32 m0, s32, 73728
    buffer_load_dwordx4 v6, s[20:23], s36 offen lds
    s_add_u32 m0, s32, 16384
    s_add_u32 s36, s32, 16384
    buffer_load_dwordx4 v6, s[16:19], s36 offen lds
    s_add_u32 m0, s32, 81920
    buffer_load_dwordx4 v6, s[20:23], s36 offen lds
    s_add_u32 m0, s32, 24576
    s_add_u32 s36, s32, 24576
    buffer_load_dwordx4 v6, s[16:19], s36 offen lds
    s_add_u32 m0, s32, 90112
    buffer_load_dwordx4 v6, s[20:23], s36 offen lds
    s_add_u32 m0, s32, 32768
    s_add_u32 s36, s32, 32768
    buffer_load_dwordx4 v6, s[16:19], s36 offen lds
    s_add_u32 m0, s32, 98304
    buffer_load_dwordx4 v6, s[20:23], s36 offen lds
    s_add_u32 m0, s32, 40960
    s_add_u32 s36, s32, 40960
    buffer_load_dwordx4 v6, s[16:19], s36 offen lds
    s_add_u32 m0, s32, 106496
    buffer_load_dwordx4 v6, s[20:23], s36 offen lds
    s_add_u32 m0, s32, 49152
    s_add_u32 s36, s32, 49152
    buffer_load_dwordx4 v6, s[16:19], s36 offen lds
    s_add_u32 m0, s32, 114688
    buffer_load_dwordx4 v6, s[20:23], s36 offen lds
    s_add_u32 m0, s32, 57344
    s_add_u32 s36, s32, 57344
    buffer_load_dwordx4 v6, s[16:19], s36 offen lds
    s_add_u32 m0, s32, 122880
    buffer_load_dwordx4 v6, s[20:23], s36 offen lds
    v_mov_b32 v12, 0x3f803f80
    v_mov_b32 v13, 0x3f803f80
    v_mov_b32 v14, 0x3f803f80
    v_mov_b32 v15, 0x3f803f80
    v_mov_b32 v7, 0x20000
    ds_write_b128 v7, v[12:15]
    ds_write_b128 v7, v[12:15] offset:512
    v_lshlrev_b32 v16, 5, v2
    v_and_b32 v16, 0x3e0, v16
    v_lshl_add_u32 v16, v4, 4, v16
    v_and_b32 v3, 31, v2
    v_and_b32 v5, 15, v2
    v_lshl_add_u32 v5, v4, 4, v5
    v_lshlrev_b32 v5, 4, v5
    v_add_u32 v5, 0x10000, v5
    v_cmp_gt_u32 vcc, 16, v3
    v_mov_b32 v7, 0x20000
    v_mov_b32 v12, 0x400
    v_cndmask_b32 v17, v7, v5, vcc
    v_cndmask_b32 v18, 0, v12, vcc
    v_mov_b32 v88, 0
    v_mov_b32 v89, 0
    v_mov_b32 v90, 0
    v_mov_b32 v91, 0
    v_mov_b32 v92, 0
    v_mov_b32 v93, 0
    v_mov_b32 v94, 0
    v_mov_b32 v95, 0
    v_mov_b32 v96, 0
    v_mov_b32 v97, 0
    v_mov_b32 v98, 0
    v_mov_b32 v99, 0
    v_mov_b32 v100, 0
    v_mov_b32 v101, 0
    v_mov_b32 v102, 0
    v_mov_b32 v103, 0
    s_mov_b32 s42, 0
    s_mov_b32 s43, 0x41000000
    s_waitcnt vmcnt(12) lgkmcnt(0)
    s_barrier
    ds_read_b128 v[24:27], v16
    ds_read_b128 v[28:31], v16 offset:1024
    ds_read_b128 v[32:35], v17
    ds_read_b128 v[36:39], v17 offset:512
    v_add_u32 v17, v17, v18
    s_waitcnt lgkmcnt(3)
    v_mfma_f32_32x32x16_bf16 v[56:71], v[24:27], v[8:11], 0
    s_nop 15
    s_nop 15
    v_max3_f32 v19, v56, v57, v58
    v_max3_f32 v19, v19, v59, v60
    v_max3_f32 v19, v19, v61, v62
    v_max3_f32 v19, v19, v63, v64
    v_max3_f32 v19, v19, v65, v66
    v_max3_f32 v19, v19, v67, v68
    v_max3_f32 v19, v19, v69, v70
    v_max_f32 v19, v19, v71
    v_mov_b32 v20, v19
    s_nop 1
    v_permlane32_swap_b32 v19, v20
    v_max_f32 v19, v19, v20
    v_sub_f32 v56, v56, v19
    v_sub_f32 v104, 0, v19
    v_sub_f32 v57, v57, v19
    v_sub_f32 v105, 0, v19
    v_sub_f32 v58, v58, v19
    v_sub_f32 v106, 0, v19
    v_sub_f32 v59, v59, v19
    v_sub_f32 v107, 0, v19
    v_sub_f32 v60, v60, v19
    v_sub_f32 v108, 0, v19
    v_sub_f32 v61, v61, v19
    v_sub_f32 v109, 0, v19
    v_sub_f32 v62, v62, v19
    v_sub_f32 v110, 0, v19
    v_sub_f32 v63, v63, v19
    v_sub_f32 v111, 0, v19
    v_sub_f32 v64, v64, v19
    v_sub_f32 v112, 0, v19
    v_sub_f32 v65, v65, v19
    v_sub_f32 v113, 0, v19
    v_sub_f32 v66, v66, v19
    v_sub_f32 v114, 0, v19
    v_sub_f32 v67, v67, v19
    v_sub_f32 v115, 0, v19
    v_sub_f32 v68, v68, v19
    v_sub_f32 v116, 0, v19
    v_sub_f32 v69, v69, v19
    v_sub_f32 v117, 0, v19
    v_sub_f32 v70, v70, v19
    v_sub_f32 v118, 0, v19
    v_sub_f32 v71, v71, v19
    v_sub_f32 v119, 0, v19
K2_CHUNK:
    ds_read_b128 v[40:43], v17
    ds_read_b128 v[44:47], v17 offset:512
    v_add_u32 v17, v17, v18
    v_max3_f32 v19, v56, v57, v58
    v_max3_f32 v19, v19, v59, v60
    v_max3_f32 v19, v19, v61, v62
    v_max3_f32 v19, v19, v63, v64
    v_max3_f32 v19, v19, v65, v66
    v_max3_f32 v19, v19, v67, v68
    v_max3_f32 v19, v19, v69, v70
    v_max_f32 v19, v19, v71
    v_cmp_lt_f32 vcc, s43, v19
    s_cbranch_vccnz K2_SLOW0
K2_FAST0:
    s_waitcnt lgkmcnt(2)
    v_mfma_f32_32x32x16_bf16 v[72:87], v[28:31], v[8:11], v[104:119]
    ds_read_b128 v[24:27], v16 offset:2048
    v_exp_f32 v56, v56
    v_exp_f32 v57, v57
    v_exp_f32 v58, v58
    v_exp_f32 v59, v59
    v_exp_f32 v60, v60
    v_exp_f32 v61, v61
    v_exp_f32 v62, v62
    v_exp_f32 v63, v63
    v_exp_f32 v64, v64
    v_cvt_pk_bf16_f32 v48, v56, v57
    v_exp_f32 v65, v65
    v_exp_f32 v66, v66
    v_cvt_pk_bf16_f32 v49, v58, v59
    v_exp_f32 v67, v67
    v_exp_f32 v68, v68
    v_cvt_pk_bf16_f32 v50, v60, v61
    v_exp_f32 v69, v69
    v_exp_f32 v70, v70
    v_cvt_pk_bf16_f32 v51, v62, v63
    v_exp_f32 v71, v71
    s_nop 0
    v_mfma_f32_32x32x16_bf16 v[88:103], v[32:35], v[48:51], v[88:103]
    v_cvt_pk_bf16_f32 v52, v64, v65
    v_cvt_pk_bf16_f32 v53, v66, v67
    v_cvt_pk_bf16_f32 v54, v68, v69
    v_cvt_pk_bf16_f32 v55, v70, v71
    s_nop 1
    v_mfma_f32_32x32x16_bf16 v[88:103], v[36:39], v[52:55], v[88:103]
    ds_read_b128 v[32:35], v17
    ds_read_b128 v[36:39], v17 offset:512
    v_add_u32 v17, v17, v18
    v_max3_f32 v19, v72, v73, v74
    v_max3_f32 v19, v19, v75, v76
    v_max3_f32 v19, v19, v77, v78
    v_max3_f32 v19, v19, v79, v80
    v_max3_f32 v19, v19, v81, v82
    v_max3_f32 v19, v19, v83, v84
    v_max3_f32 v19, v19, v85, v86
    v_max_f32 v19, v19, v87
    v_cmp_lt_f32 vcc, s43, v19
    s_cbranch_vccnz K2_SLOW1
K2_FAST1:
    s_waitcnt lgkmcnt(2)
    v_mfma_f32_32x32x16_bf16 v[56:71], v[24:27], v[8:11], v[104:119]
    ds_read_b128 v[28:31], v16 offset:3072
    v_exp_f32 v72, v72
    v_exp_f32 v73, v73
    v_exp_f32 v74, v74
    v_exp_f32 v75, v75
    v_exp_f32 v76, v76
    v_exp_f32 v77, v77
    v_exp_f32 v78, v78
    v_exp_f32 v79, v79
    v_exp_f32 v80, v80
    v_cvt_pk_bf16_f32 v48, v72, v73
    v_exp_f32 v81, v81
    v_exp_f32 v82, v82
    v_cvt_pk_bf16_f32 v49, v74, v75
    v_exp_f32 v83, v83
    v_exp_f32 v84, v84
    v_cvt_pk_bf16_f32 v50, v76, v77
    v_exp_f32 v85, v85
    v_exp_f32 v86, v86
    v_cvt_pk_bf16_f32 v51, v78, v79
    v_exp_f32 v87, v87
    s_nop 0
    v_mfma_f32_32x32x16_bf16 v[88:103], v[40:43], v[48:51], v[88:103]
    v_cvt_pk_bf16_f32 v52, v80, v81
    v_cvt_pk_bf16_f32 v53, v82, v83
    v_cvt_pk_bf16_f32 v54, v84, v85
    v_cvt_pk_bf16_f32 v55, v86, v87
    s_nop 1
    v_mfma_f32_32x32x16_bf16 v[88:103], v[44:47], v[52:55], v[88:103]
    ds_read_b128 v[40:43], v17
    ds_read_b128 v[44:47], v17 offset:512
    v_add_u32 v17, v17, v18
    v_max3_f32 v19, v56, v57, v58
    v_max3_f32 v19, v19, v59, v60
    v_max3_f32 v19, v19, v61, v62
    v_max3_f32 v19, v19, v63, v64
    v_max3_f32 v19, v19, v65, v66
    v_max3_f32 v19, v19, v67, v68
    v_max3_f32 v19, v19, v69, v70
    v_max_f32 v19, v19, v71
    v_cmp_lt_f32 vcc, s43, v19
    s_cbranch_vccnz K2_SLOW2
K2_FAST2:
    s_waitcnt lgkmcnt(2)
    v_mfma_f32_32x32x16_bf16 v[72:87], v[28:31], v[8:11], v[104:119]
    ds_read_b128 v[24:27], v16 offset:4096
    v_exp_f32 v56, v56
    v_exp_f32 v57, v57
    v_exp_f32 v58, v58
    v_exp_f32 v59, v59
    v_exp_f32 v60, v60
    v_exp_f32 v61, v61
    v_exp_f32 v62, v62
    v_exp_f32 v63, v63
    v_exp_f32 v64, v64
    v_cvt_pk_bf16_f32 v48, v56, v57
    v_exp_f32 v65, v65
    v_exp_f32 v66, v66
    v_cvt_pk_bf16_f32 v49, v58, v59
    v_exp_f32 v67, v67
    v_exp_f32 v68, v68
    v_cvt_pk_bf16_f32 v50, v60, v61
    v_exp_f32 v69, v69
    v_exp_f32 v70, v70
    v_cvt_pk_bf16_f32 v51, v62, v63
    v_exp_f32 v71, v71
    s_nop 0
    v_mfma_f32_32x32x16_bf16 v[88:103], v[32:35], v[48:51], v[88:103]
    v_cvt_pk_bf16_f32 v52, v64, v65
    v_cvt_pk_bf16_f32 v53, v66, v67
    v_cvt_pk_bf16_f32 v54, v68, v69
    v_cvt_pk_bf16_f32 v55, v70, v71
    s_nop 1
    v_mfma_f32_32x32x16_bf16 v[88:103], v[36:39], v[52:55], v[88:103]
    ds_read_b128 v[32:35], v17
    ds_read_b128 v[36:39], v17 offset:512
    v_add_u32 v17, v17, v18
    v_max3_f32 v19, v72, v73, v74
    v_max3_f32 v19, v19, v75, v76
    v_max3_f32 v19, v19, v77, v78
    v_max3_f32 v19, v19, v79, v80
    v_max3_f32 v19, v19, v81, v82
    v_max3_f32 v19, v19, v83, v84
    v_max3_f32 v19, v19, v85, v86
    v_max_f32 v19, v19, v87
    v_cmp_lt_f32 vcc, s43, v19
    s_cbranch_vccnz K2_SLOW3
K2_FAST3:
    s_waitcnt lgkmcnt(2)
    v_mfma_f32_32x32x16_bf16 v[56:71], v[24:27], v[8:11], v[104:119]
    ds_read_b128 v[28:31], v16 offset:5120
    v_exp_f32 v72, v72
    v_exp_f32 v73, v73
    v_exp_f32 v74, v74
    v_exp_f32 v75, v75
    v_exp_f32 v76, v76
    v_exp_f32 v77, v77
    v_exp_f32 v78, v78
    v_exp_f32 v79, v79
    v_exp_f32 v80, v80
    v_cvt_pk_bf16_f32 v48, v72, v73
    v_exp_f32 v81, v81
    v_exp_f32 v82, v82
    v_cvt_pk_bf16_f32 v49, v74, v75
    v_exp_f32 v83, v83
    v_exp_f32 v84, v84
    v_cvt_pk_bf16_f32 v50, v76, v77
    v_exp_f32 v85, v85
    v_exp_f32 v86, v86
    v_cvt_pk_bf16_f32 v51, v78, v79
    v_exp_f32 v87, v87
    s_nop 0
    v_mfma_f32_32x32x16_bf16 v[88:103], v[40:43], v[48:51], v[88:103]
    v_cvt_pk_bf16_f32 v52, v80, v81
    v_cvt_pk_bf16_f32 v53, v82, v83
    v_cvt_pk_bf16_f32 v54, v84, v85
    v_cvt_pk_bf16_f32 v55, v86, v87
    s_nop 1
    v_mfma_f32_32x32x16_bf16 v[88:103], v[44:47], v[52:55], v[88:103]
    ds_read_b128 v[40:43], v17
    ds_read_b128 v[44:47], v17 offset:512
    v_add_u32 v17, v17, v18
    v_max3_f32 v19, v56, v57, v58
    v_max3_f32 v19, v19, v59, v60
    v_max3_f32 v19, v19, v61, v62
    v_max3_f32 v19, v19, v63, v64
    v_max3_f32 v19, v19, v65, v66
    v_max3_f32 v19, v19, v67, v68
    v_max3_f32 v19, v19, v69, v70
    v_max_f32 v19, v19, v71
    v_cmp_lt_f32 vcc, s43, v19
    s_cbranch_vccnz K2_SLOW4
K2_FAST4:
    s_waitcnt lgkmcnt(2)
    v_mfma_f32_32x32x16_bf16 v[72:87], v[28:31], v[8:11], v[104:119]
    ds_read_b128 v[24:27], v16 offset:6144
    v_exp_f32 v56, v56
    v_exp_f32 v57, v57
    v_exp_f32 v58, v58
    v_exp_f32 v59, v59
    v_exp_f32 v60, v60
    v_exp_f32 v61, v61
    v_exp_f32 v62, v62
    v_exp_f32 v63, v63
    v_exp_f32 v64, v64
    v_cvt_pk_bf16_f32 v48, v56, v57
    v_exp_f32 v65, v65
    v_exp_f32 v66, v66
    v_cvt_pk_bf16_f32 v49, v58, v59
    v_exp_f32 v67, v67
    v_exp_f32 v68, v68
    v_cvt_pk_bf16_f32 v50, v60, v61
    v_exp_f32 v69, v69
    v_exp_f32 v70, v70
    v_cvt_pk_bf16_f32 v51, v62, v63
    v_exp_f32 v71, v71
    s_nop 0
    v_mfma_f32_32x32x16_bf16 v[88:103], v[32:35], v[48:51], v[88:103]
    v_cvt_pk_bf16_f32 v52, v64, v65
    v_cvt_pk_bf16_f32 v53, v66, v67
    v_cvt_pk_bf16_f32 v54, v68, v69
    v_cvt_pk_bf16_f32 v55, v70, v71
    s_nop 1
    v_mfma_f32_32x32x16_bf16 v[88:103], v[36:39], v[52:55], v[88:103]
    ds_read_b128 v[32:35], v17
    ds_read_b128 v[36:39], v17 offset:512
    v_add_u32 v17, v17, v18
    v_max3_f32 v19, v72, v73, v74
    v_max3_f32 v19, v19, v75, v76
    v_max3_f32 v19, v19, v77, v78
    v_max3_f32 v19, v19, v79, v80
    v_max3_f32 v19, v19, v81, v82
    v_max3_f32 v19, v19, v83, v84
    v_max3_f32 v19, v19, v85, v86
    v_max_f32 v19, v19, v87
    v_cmp_lt_f32 vcc, s43, v19
    s_cbranch_vccnz K2_SLOW5
K2_FAST5:
    s_waitcnt lgkmcnt(2)
    v_mfma_f32_32x32x16_bf16 v[56:71], v[24:27], v[8:11], v[104:119]
    ds_read_b128 v[28:31], v16 offset:7168
    v_exp_f32 v72, v72
    v_exp_f32 v73, v73
    v_exp_f32 v74, v74
    v_exp_f32 v75, v75
    v_exp_f32 v76, v76
    v_exp_f32 v77, v77
    v_exp_f32 v78, v78
    v_exp_f32 v79, v79
    v_exp_f32 v80, v80
    v_cvt_pk_bf16_f32 v48, v72, v73
    v_exp_f32 v81, v81
    v_exp_f32 v82, v82
    v_cvt_pk_bf16_f32 v49, v74, v75
    v_exp_f32 v83, v83
    v_exp_f32 v84, v84
    v_cvt_pk_bf16_f32 v50, v76, v77
    v_exp_f32 v85, v85
    v_exp_f32 v86, v86
    v_cvt_pk_bf16_f32 v51, v78, v79
    v_exp_f32 v87, v87
    s_nop 0
    v_mfma_f32_32x32x16_bf16 v[88:103], v[40:43], v[48:51], v[88:103]
    v_cvt_pk_bf16_f32 v52, v80, v81
    v_cvt_pk_bf16_f32 v53, v82, v83
    v_cvt_pk_bf16_f32 v54, v84, v85
    v_cvt_pk_bf16_f32 v55, v86, v87
    s_nop 1
    v_mfma_f32_32x32x16_bf16 v[88:103], v[44:47], v[52:55], v[88:103]
    ds_read_b128 v[40:43], v17
    ds_read_b128 v[44:47], v17 offset:512
    v_add_u32 v17, v17, v18
    v_max3_f32 v19, v56, v57, v58
    v_max3_f32 v19, v19, v59, v60
    v_max3_f32 v19, v19, v61, v62
    v_max3_f32 v19, v19, v63, v64
    v_max3_f32 v19, v19, v65, v66
    v_max3_f32 v19, v19, v67, v68
    v_max3_f32 v19, v19, v69, v70
    v_max_f32 v19, v19, v71
    v_cmp_lt_f32 vcc, s43, v19
    s_cbranch_vccnz K2_SLOW6
K2_FAST6:
    s_waitcnt lgkmcnt(2)
    v_mfma_f32_32x32x16_bf16 v[72:87], v[28:31], v[8:11], v[104:119]
    ds_read_b128 v[24:27], v16 offset:8192
    v_exp_f32 v56, v56
    v_exp_f32 v57, v57
    v_exp_f32 v58, v58
    v_exp_f32 v59, v59
    v_exp_f32 v60, v60
    v_exp_f32 v61, v61
    v_exp_f32 v62, v62
    v_exp_f32 v63, v63
    v_exp_f32 v64, v64
    v_cvt_pk_bf16_f32 v48, v56, v57
    v_exp_f32 v65, v65
    v_exp_f32 v66, v66
    v_cvt_pk_bf16_f32 v49, v58, v59
    v_exp_f32 v67, v67
    v_exp_f32 v68, v68
    v_cvt_pk_bf16_f32 v50, v60, v61
    v_exp_f32 v69, v69
    v_exp_f32 v70, v70
    v_cvt_pk_bf16_f32 v51, v62, v63
    v_exp_f32 v71, v71
    s_nop 0
    v_mfma_f32_32x32x16_bf16 v[88:103], v[32:35], v[48:51], v[88:103]
    v_cvt_pk_bf16_f32 v52, v64, v65
    v_cvt_pk_bf16_f32 v53, v66, v67
    v_cvt_pk_bf16_f32 v54, v68, v69
    v_cvt_pk_bf16_f32 v55, v70, v71
    s_nop 1
    v_mfma_f32_32x32x16_bf16 v[88:103], v[36:39], v[52:55], v[88:103]
    ds_read_b128 v[32:35], v17
    ds_read_b128 v[36:39], v17 offset:512
    v_add_u32 v17, v17, v18
    v_max3_f32 v19, v72, v73, v74
    v_max3_f32 v19, v19, v75, v76
    v_max3_f32 v19, v19, v77, v78
    v_max3_f32 v19, v19, v79, v80
    v_max3_f32 v19, v19, v81, v82
    v_max3_f32 v19, v19, v83, v84
    v_max3_f32 v19, v19, v85, v86
    v_max_f32 v19, v19, v87
    v_cmp_lt_f32 vcc, s43, v19
    s_cbranch_vccnz K2_SLOW7
K2_FAST7:
    s_waitcnt lgkmcnt(2)
    v_mfma_f32_32x32x16_bf16 v[56:71], v[24:27], v[8:11], v[104:119]
    ds_read_b128 v[28:31], v16 offset:9216
    v_exp_f32 v72, v72
    v_exp_f32 v73, v73
    v_exp_f32 v74, v74
    v_exp_f32 v75, v75
    v_exp_f32 v76, v76
    v_exp_f32 v77, v77
    v_exp_f32 v78, v78
    v_exp_f32 v79, v79
    v_exp_f32 v80, v80
    v_cvt_pk_bf16_f32 v48, v72, v73
    v_exp_f32 v81, v81
    v_exp_f32 v82, v82
    v_cvt_pk_bf16_f32 v49, v74, v75
    v_exp_f32 v83, v83
    v_exp_f32 v84, v84
    v_cvt_pk_bf16_f32 v50, v76, v77
    v_exp_f32 v85, v85
    v_exp_f32 v86, v86
    v_cvt_pk_bf16_f32 v51, v78, v79
    v_exp_f32 v87, v87
    s_nop 0
    v_mfma_f32_32x32x16_bf16 v[88:103], v[40:43], v[48:51], v[88:103]
    v_cvt_pk_bf16_f32 v52, v80, v81
    v_cvt_pk_bf16_f32 v53, v82, v83
    v_cvt_pk_bf16_f32 v54, v84, v85
    v_cvt_pk_bf16_f32 v55, v86, v87
    s_nop 1
    v_mfma_f32_32x32x16_bf16 v[88:103], v[44:47], v[52:55], v[88:103]
    v_add_u32 v16, 0x2000, v16
    s_add_u32 s42, s42, 1
    s_cmp_eq_u32 s42, 8
    s_cbranch_scc1 K2_EPI
    s_cmp_eq_u32 s42, 1
    s_cbranch_scc0 K2_W1
    s_waitcnt vmcnt(10)
K2_W1:
    s_cmp_eq_u32 s42, 2
    s_cbranch_scc0 K2_W2
    s_waitcnt vmcnt(8)
K2_W2:
    s_cmp_eq_u32 s42, 3
    s_cbranch_scc0 K2_W3
    s_waitcnt vmcnt(6)
K2_W3:
    s_cmp_eq_u32 s42, 4
    s_cbranch_scc0 K2_W4
    s_waitcnt vmcnt(4)
K2_W4:
    s_cmp_eq_u32 s42, 5
    s_cbranch_scc0 K2_W5
    s_waitcnt vmcnt(2)
K2_W5:
    s_cmp_eq_u32 s42, 6
    s_cbranch_scc0 K2_W6
    s_waitcnt vmcnt(0)
K2_W6:
    s_barrier
    s_branch K2_CHUNK
K2_SLOW0:
    v_mov_b32 v20, v19
    s_nop 1
    v_permlane32_swap_b32 v19, v20
    v_max_f32 v19, v19, v20
    v_max_f32 v19, 0, v19
    v_sub_f32 v20, 0, v19
    v_exp_f32 v20, v20
    s_nop 7
    s_nop 7
    v_sub_f32 v56, v56, v19
    v_sub_f32 v104, v104, v19
    v_sub_f32 v57, v57, v19
    v_sub_f32 v105, v105, v19
    v_sub_f32 v58, v58, v19
    v_sub_f32 v106, v106, v19
    v_sub_f32 v59, v59, v19
    v_sub_f32 v107, v107, v19
    v_sub_f32 v60, v60, v19
    v_sub_f32 v108, v108, v19
    v_sub_f32 v61, v61, v19
    v_sub_f32 v109, v109, v19
    v_sub_f32 v62, v62, v19
    v_sub_f32 v110, v110, v19
    v_sub_f32 v63, v63, v19
    v_sub_f32 v111, v111, v19
    v_sub_f32 v64, v64, v19
    v_sub_f32 v112, v112, v19
    v_sub_f32 v65, v65, v19
    v_sub_f32 v113, v113, v19
    v_sub_f32 v66, v66, v19
    v_sub_f32 v114, v114, v19
    v_sub_f32 v67, v67, v19
    v_sub_f32 v115, v115, v19
    v_sub_f32 v68, v68, v19
    v_sub_f32 v116, v116, v19
    v_sub_f32 v69, v69, v19
    v_sub_f32 v117, v117, v19
    v_sub_f32 v70, v70, v19
    v_sub_f32 v118, v118, v19
    v_sub_f32 v71, v71, v19
    v_sub_f32 v119, v119, v19
    v_mul_f32 v88, v88, v20
    v_mul_f32 v89, v89, v20
    v_mul_f32 v90, v90, v20
    v_mul_f32 v91, v91, v20
    v_mul_f32 v92, v92, v20
    v_mul_f32 v93, v93, v20
    v_mul_f32 v94, v94, v20
    v_mul_f32 v95, v95, v20
    v_mul_f32 v96, v96, v20
    s_nop 1
    s_branch K2_FAST0
K2_SLOW1:
    v_mov_b32 v20, v19
    s_nop 1
    v_permlane32_swap_b32 v19, v20
    v_max_f32 v19, v19, v20
    v_max_f32 v19, 0, v19
    v_sub_f32 v20, 0, v19
    v_exp_f32 v20, v20
    s_nop 7
    s_nop 7
    v_sub_f32 v72, v72, v19
    v_sub_f32 v104, v104, v19
    v_sub_f32 v73, v73, v19
    v_sub_f32 v105, v105, v19
    v_sub_f32 v74, v74, v19
    v_sub_f32 v106, v106, v19
    v_sub_f32 v75, v75, v19
    v_sub_f32 v107, v107, v19
    v_sub_f32 v76, v76, v19
    v_sub_f32 v108, v108, v19
    v_sub_f32 v77, v77, v19
    v_sub_f32 v109, v109, v19
    v_sub_f32 v78, v78, v19
    v_sub_f32 v110, v110, v19
    v_sub_f32 v79, v79, v19
    v_sub_f32 v111, v111, v19
    v_sub_f32 v80, v80, v19
    v_sub_f32 v112, v112, v19
    v_sub_f32 v81, v81, v19
    v_sub_f32 v113, v113, v19
    v_sub_f32 v82, v82, v19
    v_sub_f32 v114, v114, v19
    v_sub_f32 v83, v83, v19
    v_sub_f32 v115, v115, v19
    v_sub_f32 v84, v84, v19
    v_sub_f32 v116, v116, v19
    v_sub_f32 v85, v85, v19
    v_sub_f32 v117, v117, v19
    v_sub_f32 v86, v86, v19
    v_sub_f32 v118, v118, v19
    v_sub_f32 v87, v87, v19
    v_sub_f32 v119, v119, v19
    v_mul_f32 v88, v88, v20
    v_mul_f32 v89, v89, v20
    v_mul_f32 v90, v90, v20
    v_mul_f32 v91, v91, v20
    v_mul_f32 v92, v92, v20
    v_mul_f32 v93, v93, v20
    v_mul_f32 v94, v94, v20
    v_mul_f32 v95, v95, v20
    v_mul_f32 v96, v96, v20
    s_nop 1
    s_branch K2_FAST1
K2_SLOW2:
    v_mov_b32 v20, v19
    s_nop 1
    v_permlane32_swap_b32 v19, v20
    v_max_f32 v19, v19, v20
    v_max_f32 v19, 0, v19
    v_sub_f32 v20, 0, v19
    v_exp_f32 v20, v20
    s_nop 7
    s_nop 7
    v_sub_f32 v56, v56, v19
    v_sub_f32 v104, v104, v19
    v_sub_f32 v57, v57, v19
    v_sub_f32 v105, v105, v19
    v_sub_f32 v58, v58, v19
    v_sub_f32 v106, v106, v19
    v_sub_f32 v59, v59, v19
    v_sub_f32 v107, v107, v19
    v_sub_f32 v60, v60, v19
    v_sub_f32 v108, v108, v19
    v_sub_f32 v61, v61, v19
    v_sub_f32 v109, v109, v19
    v_sub_f32 v62, v62, v19
    v_sub_f32 v110, v110, v19
    v_sub_f32 v63, v63, v19
    v_sub_f32 v111, v111, v19
    v_sub_f32 v64, v64, v19
    v_sub_f32 v112, v112, v19
    v_sub_f32 v65, v65, v19
    v_sub_f32 v113, v113, v19
    v_sub_f32 v66, v66, v19
    v_sub_f32 v114, v114, v19
    v_sub_f32 v67, v67, v19
    v_sub_f32 v115, v115, v19
    v_sub_f32 v68, v68, v19
    v_sub_f32 v116, v116, v19
    v_sub_f32 v69, v69, v19
    v_sub_f32 v117, v117, v19
    v_sub_f32 v70, v70, v19
    v_sub_f32 v118, v118, v19
    v_sub_f32 v71, v71, v19
    v_sub_f32 v119, v119, v19
    v_mul_f32 v88, v88, v20
    v_mul_f32 v89, v89, v20
    v_mul_f32 v90, v90, v20
    v_mul_f32 v91, v91, v20
    v_mul_f32 v92, v92, v20
    v_mul_f32 v93, v93, v20
    v_mul_f32 v94, v94, v20
    v_mul_f32 v95, v95, v20
    v_mul_f32 v96, v96, v20
    s_nop 1
    s_branch K2_FAST2
K2_SLOW3:
    v_mov_b32 v20, v19
    s_nop 1
    v_permlane32_swap_b32 v19, v20
    v_max_f32 v19, v19, v20
    v_max_f32 v19, 0, v19
    v_sub_f32 v20, 0, v19
    v_exp_f32 v20, v20
    s_nop 7
    s_nop 7
    v_sub_f32 v72, v72, v19
    v_sub_f32 v104, v104, v19
    v_sub_f32 v73, v73, v19
    v_sub_f32 v105, v105, v19
    v_sub_f32 v74, v74, v19
    v_sub_f32 v106, v106, v19
    v_sub_f32 v75, v75, v19
    v_sub_f32 v107, v107, v19
    v_sub_f32 v76, v76, v19
    v_sub_f32 v108, v108, v19
    v_sub_f32 v77, v77, v19
    v_sub_f32 v109, v109, v19
    v_sub_f32 v78, v78, v19
    v_sub_f32 v110, v110, v19
    v_sub_f32 v79, v79, v19
    v_sub_f32 v111, v111, v19
    v_sub_f32 v80, v80, v19
    v_sub_f32 v112, v112, v19
    v_sub_f32 v81, v81, v19
    v_sub_f32 v113, v113, v19
    v_sub_f32 v82, v82, v19
    v_sub_f32 v114, v114, v19
    v_sub_f32 v83, v83, v19
    v_sub_f32 v115, v115, v19
    v_sub_f32 v84, v84, v19
    v_sub_f32 v116, v116, v19
    v_sub_f32 v85, v85, v19
    v_sub_f32 v117, v117, v19
    v_sub_f32 v86, v86, v19
    v_sub_f32 v118, v118, v19
    v_sub_f32 v87, v87, v19
    v_sub_f32 v119, v119, v19
    v_mul_f32 v88, v88, v20
    v_mul_f32 v89, v89, v20
    v_mul_f32 v90, v90, v20
    v_mul_f32 v91, v91, v20
    v_mul_f32 v92, v92, v20
    v_mul_f32 v93, v93, v20
    v_mul_f32 v94, v94, v20
    v_mul_f32 v95, v95, v20
    v_mul_f32 v96, v96, v20
    s_nop 1
    s_branch K2_FAST3
K2_SLOW4:
    v_mov_b32 v20, v19
    s_nop 1
    v_permlane32_swap_b32 v19, v20
    v_max_f32 v19, v19, v20
    v_max_f32 v19, 0, v19
    v_sub_f32 v20, 0, v19
    v_exp_f32 v20, v20
    s_nop 7
    s_nop 7
    v_sub_f32 v56, v56, v19
    v_sub_f32 v104, v104, v19
    v_sub_f32 v57, v57, v19
    v_sub_f32 v105, v105, v19
    v_sub_f32 v58, v58, v19
    v_sub_f32 v106, v106, v19
    v_sub_f32 v59, v59, v19
    v_sub_f32 v107, v107, v19
    v_sub_f32 v60, v60, v19
    v_sub_f32 v108, v108, v19
    v_sub_f32 v61, v61, v19
    v_sub_f32 v109, v109, v19
    v_sub_f32 v62, v62, v19
    v_sub_f32 v110, v110, v19
    v_sub_f32 v63, v63, v19
    v_sub_f32 v111, v111, v19
    v_sub_f32 v64, v64, v19
    v_sub_f32 v112, v112, v19
    v_sub_f32 v65, v65, v19
    v_sub_f32 v113, v113, v19
    v_sub_f32 v66, v66, v19
    v_sub_f32 v114, v114, v19
    v_sub_f32 v67, v67, v19
    v_sub_f32 v115, v115, v19
    v_sub_f32 v68, v68, v19
    v_sub_f32 v116, v116, v19
    v_sub_f32 v69, v69, v19
    v_sub_f32 v117, v117, v19
    v_sub_f32 v70, v70, v19
    v_sub_f32 v118, v118, v19
    v_sub_f32 v71, v71, v19
    v_sub_f32 v119, v119, v19
    v_mul_f32 v88, v88, v20
    v_mul_f32 v89, v89, v20
    v_mul_f32 v90, v90, v20
    v_mul_f32 v91, v91, v20
    v_mul_f32 v92, v92, v20
    v_mul_f32 v93, v93, v20
    v_mul_f32 v94, v94, v20
    v_mul_f32 v95, v95, v20
    v_mul_f32 v96, v96, v20
    s_nop 1
    s_branch K2_FAST4
K2_SLOW5:
    v_mov_b32 v20, v19
    s_nop 1
    v_permlane32_swap_b32 v19, v20
    v_max_f32 v19, v19, v20
    v_max_f32 v19, 0, v19
    v_sub_f32 v20, 0, v19
    v_exp_f32 v20, v20
    s_nop 7
    s_nop 7
    v_sub_f32 v72, v72, v19
    v_sub_f32 v104, v104, v19
    v_sub_f32 v73, v73, v19
    v_sub_f32 v105, v105, v19
    v_sub_f32 v74, v74, v19
    v_sub_f32 v106, v106, v19
    v_sub_f32 v75, v75, v19
    v_sub_f32 v107, v107, v19
    v_sub_f32 v76, v76, v19
    v_sub_f32 v108, v108, v19
    v_sub_f32 v77, v77, v19
    v_sub_f32 v109, v109, v19
    v_sub_f32 v78, v78, v19
    v_sub_f32 v110, v110, v19
    v_sub_f32 v79, v79, v19
    v_sub_f32 v111, v111, v19
    v_sub_f32 v80, v80, v19
    v_sub_f32 v112, v112, v19
    v_sub_f32 v81, v81, v19
    v_sub_f32 v113, v113, v19
    v_sub_f32 v82, v82, v19
    v_sub_f32 v114, v114, v19
    v_sub_f32 v83, v83, v19
    v_sub_f32 v115, v115, v19
    v_sub_f32 v84, v84, v19
    v_sub_f32 v116, v116, v19
    v_sub_f32 v85, v85, v19
    v_sub_f32 v117, v117, v19
    v_sub_f32 v86, v86, v19
    v_sub_f32 v118, v118, v19
    v_sub_f32 v87, v87, v19
    v_sub_f32 v119, v119, v19
    v_mul_f32 v88, v88, v20
    v_mul_f32 v89, v89, v20
    v_mul_f32 v90, v90, v20
    v_mul_f32 v91, v91, v20
    v_mul_f32 v92, v92, v20
    v_mul_f32 v93, v93, v20
    v_mul_f32 v94, v94, v20
    v_mul_f32 v95, v95, v20
    v_mul_f32 v96, v96, v20
    s_nop 1
    s_branch K2_FAST5
K2_SLOW6:
    v_mov_b32 v20, v19
    s_nop 1
    v_permlane32_swap_b32 v19, v20
    v_max_f32 v19, v19, v20
    v_max_f32 v19, 0, v19
    v_sub_f32 v20, 0, v19
    v_exp_f32 v20, v20
    s_nop 7
    s_nop 7
    v_sub_f32 v56, v56, v19
    v_sub_f32 v104, v104, v19
    v_sub_f32 v57, v57, v19
    v_sub_f32 v105, v105, v19
    v_sub_f32 v58, v58, v19
    v_sub_f32 v106, v106, v19
    v_sub_f32 v59, v59, v19
    v_sub_f32 v107, v107, v19
    v_sub_f32 v60, v60, v19
    v_sub_f32 v108, v108, v19
    v_sub_f32 v61, v61, v19
    v_sub_f32 v109, v109, v19
    v_sub_f32 v62, v62, v19
    v_sub_f32 v110, v110, v19
    v_sub_f32 v63, v63, v19
    v_sub_f32 v111, v111, v19
    v_sub_f32 v64, v64, v19
    v_sub_f32 v112, v112, v19
    v_sub_f32 v65, v65, v19
    v_sub_f32 v113, v113, v19
    v_sub_f32 v66, v66, v19
    v_sub_f32 v114, v114, v19
    v_sub_f32 v67, v67, v19
    v_sub_f32 v115, v115, v19
    v_sub_f32 v68, v68, v19
    v_sub_f32 v116, v116, v19
    v_sub_f32 v69, v69, v19
    v_sub_f32 v117, v117, v19
    v_sub_f32 v70, v70, v19
    v_sub_f32 v118, v118, v19
    v_sub_f32 v71, v71, v19
    v_sub_f32 v119, v119, v19
    v_mul_f32 v88, v88, v20
    v_mul_f32 v89, v89, v20
    v_mul_f32 v90, v90, v20
    v_mul_f32 v91, v91, v20
    v_mul_f32 v92, v92, v20
    v_mul_f32 v93, v93, v20
    v_mul_f32 v94, v94, v20
    v_mul_f32 v95, v95, v20
    v_mul_f32 v96, v96, v20
    s_nop 1
    s_branch K2_FAST6
K2_SLOW7:
    v_mov_b32 v20, v19
    s_nop 1
    v_permlane32_swap_b32 v19, v20
    v_max_f32 v19, v19, v20
    v_max_f32 v19, 0, v19
    v_sub_f32 v20, 0, v19
    v_exp_f32 v20, v20
    s_nop 7
    s_nop 7
    v_sub_f32 v72, v72, v19
    v_sub_f32 v104, v104, v19
    v_sub_f32 v73, v73, v19
    v_sub_f32 v105, v105, v19
    v_sub_f32 v74, v74, v19
    v_sub_f32 v106, v106, v19
    v_sub_f32 v75, v75, v19
    v_sub_f32 v107, v107, v19
    v_sub_f32 v76, v76, v19
    v_sub_f32 v108, v108, v19
    v_sub_f32 v77, v77, v19
    v_sub_f32 v109, v109, v19
    v_sub_f32 v78, v78, v19
    v_sub_f32 v110, v110, v19
    v_sub_f32 v79, v79, v19
    v_sub_f32 v111, v111, v19
    v_sub_f32 v80, v80, v19
    v_sub_f32 v112, v112, v19
    v_sub_f32 v81, v81, v19
    v_sub_f32 v113, v113, v19
    v_sub_f32 v82, v82, v19
    v_sub_f32 v114, v114, v19
    v_sub_f32 v83, v83, v19
    v_sub_f32 v115, v115, v19
    v_sub_f32 v84, v84, v19
    v_sub_f32 v116, v116, v19
    v_sub_f32 v85, v85, v19
    v_sub_f32 v117, v117, v19
    v_sub_f32 v86, v86, v19
    v_sub_f32 v118, v118, v19
    v_sub_f32 v87, v87, v19
    v_sub_f32 v119, v119, v19
    v_mul_f32 v88, v88, v20
    v_mul_f32 v89, v89, v20
    v_mul_f32 v90, v90, v20
    v_mul_f32 v91, v91, v20
    v_mul_f32 v92, v92, v20
    v_mul_f32 v93, v93, v20
    v_mul_f32 v94, v94, v20
    v_mul_f32 v95, v95, v20
    v_mul_f32 v96, v96, v20
    s_nop 1
    s_branch K2_FAST7
K2_EPI:
    s_nop 15
    s_nop 15
    v_rcp_f32 v19, v96
    s_nop 0
    v_mul_f32 v88, v88, v19
    v_mul_f32 v89, v89, v19
    v_mul_f32 v90, v90, v19
    v_mul_f32 v91, v91, v19
    v_mul_f32 v92, v92, v19
    v_mul_f32 v93, v93, v19
    v_mul_f32 v94, v94, v19
    v_mul_f32 v95, v95, v19
    v_cvt_pk_bf16_f32 v48, v88, v89
    v_cvt_pk_bf16_f32 v49, v90, v91
    v_cvt_pk_bf16_f32 v50, v92, v93
    v_cvt_pk_bf16_f32 v51, v94, v95
    s_nop 1
    v_permlane32_swap_b32 v48, v50
    v_permlane32_swap_b32 v49, v51
    s_add_u32 s24, s12, 0x600000
    s_addc_u32 s25, s13, 0
    s_mov_b32 s26, 0x200000
    s_mov_b32 s27, 0x00020000
    v_and_b32 v3, 31, v2
    v_lshrrev_b32 v4, 5, v2
    v_add_u32 v3, s35, v3
    v_lshlrev_b32 v5, 10, v3
    v_lshl_add_u32 v5, v4, 4, v5
    s_lshl_b32 s36, s28, 5
    buffer_store_dwordx4 v[48:51], v5, s[24:27], s36 offen
K2_DONE:
    s_endpgm
.globl k3_out_kernel
.p2align 8
.type k3_out_kernel,@function
k3_out_kernel:
    s_load_dwordx2 s[4:5], s[0:1], 16
    s_load_dwordx2 s[6:7], s[0:1], 40
    s_load_dwordx2 s[8:9], s[0:1], 56
    s_load_dwordx2 s[12:13], s[0:1], 72
    s_cmp_ge_u32 s2, 256
    s_cbranch_scc1 K3_DONE
    v_lshrrev_b32 v1, 6, v0
    v_and_b32 v2, 63, v0
    v_readfirstlane_b32 s31, v1
    s_and_b32 s28, s2, 7
    s_lshl_b32 s28, s28, 2
    s_lshr_b32 s29, s2, 6
    s_add_u32 s28, s28, s29
    s_lshr_b32 s29, s2, 3
    s_and_b32 s29, s29, 7
    s_waitcnt lgkmcnt(0)
    s_add_u32 s16, s12, 0x600000
    s_addc_u32 s17, s13, 0
    s_mov_b32 s18, 0x200000
    s_mov_b32 s19, 0x00020000
    s_add_u32 s20, s12, 0x900000
    s_addc_u32 s21, s13, 0
    s_mov_b32 s22, 0x580000
    s_mov_b32 s23, 0x00020000
    s_mov_b32 s24, s4
    s_mov_b32 s25, s5
    s_mov_b32 s26, 0x80000
    s_mov_b32 s27, 0x00020000
    s_mov_b32 s44, s6
    s_mov_b32 s45, s7
    s_mov_b32 s46, 0x158000
    s_mov_b32 s47, 0x00020000
    v_lshrrev_b32 v3, 3, v2
    v_and_b32 v4, 7, v2
    v_lshrrev_b32 v5, 4, v2
    v_xor_b32 v6, v4, v5
    v_lshlrev_b32 v6, 4, v6
    v_lshl_add_u32 v8, v3, 10, v6
    v_xor_b32 v9, 64, v8
    s_movk_i32 s35, 2816
    v_mul_lo_u32 v7, v3, s35
    v_add_u32 v10, v7, v6
    v_xor_b32 v6, 64, v6
    v_add_u32 v11, v7, v6
    v_lshrrev_b32 v5, 1, v3
    v_and_b32 v5, 1, v5
    v_lshlrev_b32 v5, 2, v5
    v_xor_b32 v5, v5, v4
    v_lshlrev_b32 v5, 4, v5
    v_lshl_add_u32 v12, v3, 10, v5
    s_lshl_b32 s32, s31, 11
    s_lshl_b32 s33, s28, 6
    s_lshl_b32 s35, s31, 4
    s_add_u32 s33, s33, s35
    s_lshl_b32 s34, s33, 10
    s_mul_i32 s36, s33, 2816
    s_lshl_b32 s37, s29, 7
    s_lshl_b32 s35, s31, 14
    s_add_u32 s37, s37, s35
    s_lshr_b32 s38, s31, 1
    s_and_b32 s39, s31, 1
    v_and_b32 v3, 31, v2
    v_lshrrev_b32 v4, 5, v2
    v_lshrrev_b32 v5, 1, v3
    v_and_b32 v5, 7, v5
    s_lshl_b32 s35, s38, 12
    v_lshlrev_b32 v6, 7, v3
    v_add_u32 v6, s35, v6
    v_add_u32 v13, 0, v4
    v_xor_b32 v13, v13, v5
    v_lshl_add_u32 v13, v13, 4, v6
    v_add_u32 v14, 2, v4
    v_xor_b32 v14, v14, v5
    v_lshl_add_u32 v14, v14, 4, v6
    v_add_u32 v15, 4, v4
    v_xor_b32 v15, v15, v5
    v_lshl_add_u32 v15, v15, 4, v6
    v_add_u32 v16, 6, v4
    v_xor_b32 v16, v16, v5
    v_lshl_add_u32 v16, v16, 4, v6
    v_lshrrev_b32 v3, 4, v2
    v_and_b32 v4, 1, v3
    v_lshrrev_b32 v3, 1, v3
    v_and_b32 v5, 15, v2
    v_lshrrev_b32 v6, 2, v5
    v_and_b32 v5, 3, v5
    v_lshl_add_u32 v7, v3, 3, v6
    v_lshlrev_b32 v7, 7, v7
    v_lshl_add_u32 v7, v4, 5, v7
    v_lshl_add_u32 v7, v5, 3, v7
    v_lshrrev_b32 v6, 1, v6
    v_xor_b32 v6, s39, v6
    v_lshl_add_u32 v17, v6, 6, v7
    v_add_u32 v17, 0x2000, v17
    v_add_u32 v18, 0x10000, v13
    v_add_u32 v19, 0x10000, v14
    v_add_u32 v20, 0x10000, v15
    v_add_u32 v21, 0x10000, v16
    v_add_u32 v22, 0x10000, v17
    v_mov_b32 v64, 0
    v_mov_b32 v65, 0
    v_mov_b32 v66, 0
    v_mov_b32 v67, 0
    v_mov_b32 v68, 0
    v_mov_b32 v69, 0
    v_mov_b32 v70, 0
    v_mov_b32 v71, 0
    v_mov_b32 v72, 0
    v_mov_b32 v73, 0
    v_mov_b32 v74, 0
    v_mov_b32 v75, 0
    v_mov_b32 v76, 0
    v_mov_b32 v77, 0
    v_mov_b32 v78, 0
    v_mov_b32 v79, 0
    v_mov_b32 v80, 0
    v_mov_b32 v81, 0
    v_mov_b32 v82, 0
    v_mov_b32 v83, 0
    v_mov_b32 v84, 0
    v_mov_b32 v85, 0
    v_mov_b32 v86, 0
    v_mov_b32 v87, 0
    v_mov_b32 v88, 0
    v_mov_b32 v89, 0
    v_mov_b32 v90, 0
    v_mov_b32 v91, 0
    v_mov_b32 v92, 0
    v_mov_b32 v93, 0
    v_mov_b32 v94, 0
    v_mov_b32 v95, 0
    s_add_u32 m0, s32, 0
    s_add_u32 s35, s34, 0
    buffer_load_dwordx4 v8, s[16:19], s35 offen lds
    s_add_u32 m0, s32, 1024
    s_add_u32 s35, s34, 8192
    buffer_load_dwordx4 v9, s[16:19], s35 offen lds
    s_add_u32 m0, s32, 8192
    s_add_u32 s35, s37, 0
    buffer_load_dwordx4 v12, s[24:27], s35 offen lds
    s_add_u32 m0, s32, 9216
    s_add_u32 s35, s37, 8192
    buffer_load_dwordx4 v12, s[24:27], s35 offen lds
    s_add_u32 m0, s32, 16384
    s_add_u32 s35, s34, 128
    buffer_load_dwordx4 v8, s[16:19], s35 offen lds
    s_add_u32 m0, s32, 17408
    s_add_u32 s35, s34, 8320
    buffer_load_dwordx4 v9, s[16:19], s35 offen lds
    s_add_u32 m0, s32, 24576
    s_add_u32 s35, s37, 65536
    buffer_load_dwordx4 v12, s[24:27], s35 offen lds
    s_add_u32 m0, s32, 25600
    s_add_u32 s35, s37, 73728
    buffer_load_dwordx4 v12, s[24:27], s35 offen lds
    s_add_u32 m0, s32, 32768
    s_add_u32 s35, s34, 256
    buffer_load_dwordx4 v8, s[16:19], s35 offen lds
    s_add_u32 m0, s32, 33792
    s_add_u32 s35, s34, 8448
    buffer_load_dwordx4 v9, s[16:19], s35 offen lds
    s_add_u32 m0, s32, 40960
    s_add_u32 s35, s37, 131072
    buffer_load_dwordx4 v12, s[24:27], s35 offen lds
    s_add_u32 m0, s32, 41984
    s_add_u32 s35, s37, 139264
    buffer_load_dwordx4 v12, s[24:27], s35 offen lds
    s_add_u32 m0, s32, 49152
    s_add_u32 s35, s34, 384
    buffer_load_dwordx4 v8, s[16:19], s35 offen lds
    s_add_u32 m0, s32, 50176
    s_add_u32 s35, s34, 8576
    buffer_load_dwordx4 v9, s[16:19], s35 offen lds
    s_add_u32 m0, s32, 57344
    s_add_u32 s35, s37, 196608
    buffer_load_dwordx4 v12, s[24:27], s35 offen lds
    s_add_u32 m0, s32, 58368
    s_add_u32 s35, s37, 204800
    buffer_load_dwordx4 v12, s[24:27], s35 offen lds
    s_add_u32 m0, s32, 65536
    s_add_u32 s35, s34, 512
    buffer_load_dwordx4 v8, s[16:19], s35 offen lds
    s_add_u32 m0, s32, 66560
    s_add_u32 s35, s34, 8704
    buffer_load_dwordx4 v9, s[16:19], s35 offen lds
    s_add_u32 m0, s32, 73728
    s_add_u32 s35, s37, 262144
    buffer_load_dwordx4 v12, s[24:27], s35 offen lds
    s_add_u32 m0, s32, 74752
    s_add_u32 s35, s37, 270336
    buffer_load_dwordx4 v12, s[24:27], s35 offen lds
    s_add_u32 m0, s32, 81920
    s_add_u32 s35, s34, 640
    buffer_load_dwordx4 v8, s[16:19], s35 offen lds
    s_add_u32 m0, s32, 82944
    s_add_u32 s35, s34, 8832
    buffer_load_dwordx4 v9, s[16:19], s35 offen lds
    s_add_u32 m0, s32, 90112
    s_add_u32 s35, s37, 327680
    buffer_load_dwordx4 v12, s[24:27], s35 offen lds
    s_add_u32 m0, s32, 91136
    s_add_u32 s35, s37, 335872
    buffer_load_dwordx4 v12, s[24:27], s35 offen lds
    s_add_u32 m0, s32, 98304
    s_add_u32 s35, s34, 768
    buffer_load_dwordx4 v8, s[16:19], s35 offen lds
    s_add_u32 m0, s32, 99328
    s_add_u32 s35, s34, 8960
    buffer_load_dwordx4 v9, s[16:19], s35 offen lds
    s_add_u32 m0, s32, 106496
    s_add_u32 s35, s37, 393216
    buffer_load_dwordx4 v12, s[24:27], s35 offen lds
    s_add_u32 m0, s32, 107520
    s_add_u32 s35, s37, 401408
    buffer_load_dwordx4 v12, s[24:27], s35 offen lds
    s_waitcnt vmcnt(24)
    s_barrier
    ds_read_b128 v[32:35], v13 offset:0
    ds_read_b64_tr_b16 v[36:37], v17 offset:0
    ds_read_b64_tr_b16 v[38:39], v17 offset:512
    ds_read_b128 v[40:43], v14 offset:0
    ds_read_b64_tr_b16 v[44:45], v17 offset:2048
    ds_read_b64_tr_b16 v[46:47], v17 offset:2560
    ds_read_b128 v[48:51], v15 offset:0
    ds_read_b64_tr_b16 v[52:53], v17 offset:4096
    ds_read_b64_tr_b16 v[54:55], v17 offset:4608
    ds_read_b128 v[56:59], v16 offset:0
    ds_read_b64_tr_b16 v[60:61], v17 offset:6144
    ds_read_b64_tr_b16 v[62:63], v17 offset:6656
    s_waitcnt vmcnt(20) lgkmcnt(0)
    s_barrier
    s_add_u32 m0, s32, 114688
    s_add_u32 s35, s34, 896
    buffer_load_dwordx4 v8, s[16:19], s35 offen lds
    s_add_u32 m0, s32, 115712
    s_add_u32 s35, s34, 9088
    buffer_load_dwordx4 v9, s[16:19], s35 offen lds
    s_add_u32 m0, s32, 122880
    s_add_u32 s35, s37, 458752
    buffer_load_dwordx4 v12, s[24:27], s35 offen lds
    s_add_u32 m0, s32, 123904
    s_add_u32 s35, s37, 466944
    buffer_load_dwordx4 v12, s[24:27], s35 offen lds
    ds_read_b128 v[96:99], v13 offset:16384
    ds_read_b64_tr_b16 v[100:101], v17 offset:16384
    ds_read_b64_tr_b16 v[102:103], v17 offset:16896
    ds_read_b128 v[104:107], v14 offset:16384
    ds_read_b64_tr_b16 v[108:109], v17 offset:18432
    ds_read_b64_tr_b16 v[110:111], v17 offset:18944
    ds_read_b128 v[112:115], v15 offset:16384
    ds_read_b64_tr_b16 v[116:117], v17 offset:20480
    ds_read_b64_tr_b16 v[118:119], v17 offset:20992
    ds_read_b128 v[120:123], v16 offset:16384
    ds_read_b64_tr_b16 v[124:125], v17 offset:22528
    ds_read_b64_tr_b16 v[126:127], v17 offset:23040
    v_mfma_f32_32x32x16_bf16 v[64:79], v[36:39], v[32:35], v[64:79]
    v_mfma_f32_32x32x16_bf16 v[64:79], v[44:47], v[40:43], v[64:79]
    v_mfma_f32_32x32x16_bf16 v[64:79], v[52:55], v[48:51], v[64:79]
    v_mfma_f32_32x32x16_bf16 v[64:79], v[60:63], v[56:59], v[64:79]
    s_waitcnt vmcnt(20) lgkmcnt(0)
    s_barrier
    s_add_u32 m0, s32, 0
    s_add_u32 s35, s36, 0
    buffer_load_dwordx4 v10, s[20:23], s35 offen lds
    s_add_u32 m0, s32, 1024
    s_add_u32 s35, s36, 22528
    buffer_load_dwordx4 v11, s[20:23], s35 offen lds
    s_add_u32 m0, s32, 8192
    s_add_u32 s35, s37, 0
    buffer_load_dwordx4 v12, s[44:47], s35 offen lds
    s_add_u32 m0, s32, 9216
    s_add_u32 s35, s37, 8192
    buffer_load_dwordx4 v12, s[44:47], s35 offen lds
    ds_read_b128 v[32:35], v13 offset:32768
    ds_read_b64_tr_b16 v[36:37], v17 offset:32768
    ds_read_b64_tr_b16 v[38:39], v17 offset:33280
    ds_read_b128 v[40:43], v14 offset:32768
    ds_read_b64_tr_b16 v[44:45], v17 offset:34816
    ds_read_b64_tr_b16 v[46:47], v17 offset:35328
    ds_read_b128 v[48:51], v15 offset:32768
    ds_read_b64_tr_b16 v[52:53], v17 offset:36864
    ds_read_b64_tr_b16 v[54:55], v17 offset:37376
    ds_read_b128 v[56:59], v16 offset:32768
    ds_read_b64_tr_b16 v[60:61], v17 offset:38912
    ds_read_b64_tr_b16 v[62:63], v17 offset:39424
    v_mfma_f32_32x32x16_bf16 v[64:79], v[100:103], v[96:99], v[64:79]
    v_mfma_f32_32x32x16_bf16 v[64:79], v[108:111], v[104:107], v[64:79]
    v_mfma_f32_32x32x16_bf16 v[64:79], v[116:119], v[112:115], v[64:79]
    v_mfma_f32_32x32x16_bf16 v[64:79], v[124:127], v[120:123], v[64:79]
    s_waitcnt vmcnt(20) lgkmcnt(0)
    s_barrier
    s_add_u32 m0, s32, 16384
    s_add_u32 s35, s36, 128
    buffer_load_dwordx4 v10, s[20:23], s35 offen lds
    s_add_u32 m0, s32, 17408
    s_add_u32 s35, s36, 22656
    buffer_load_dwordx4 v11, s[20:23], s35 offen lds
    s_add_u32 m0, s32, 24576
    s_add_u32 s35, s37, 65536
    buffer_load_dwordx4 v12, s[44:47], s35 offen lds
    s_add_u32 m0, s32, 25600
    s_add_u32 s35, s37, 73728
    buffer_load_dwordx4 v12, s[44:47], s35 offen lds
    ds_read_b128 v[96:99], v13 offset:49152
    ds_read_b64_tr_b16 v[100:101], v17 offset:49152
    ds_read_b64_tr_b16 v[102:103], v17 offset:49664
    ds_read_b128 v[104:107], v14 offset:49152
    ds_read_b64_tr_b16 v[108:109], v17 offset:51200
    ds_read_b64_tr_b16 v[110:111], v17 offset:51712
    ds_read_b128 v[112:115], v15 offset:49152
    ds_read_b64_tr_b16 v[116:117], v17 offset:53248
    ds_read_b64_tr_b16 v[118:119], v17 offset:53760
    ds_read_b128 v[120:123], v16 offset:49152
    ds_read_b64_tr_b16 v[124:125], v17 offset:55296
    ds_read_b64_tr_b16 v[126:127], v17 offset:55808
    v_mfma_f32_32x32x16_bf16 v[64:79], v[36:39], v[32:35], v[64:79]
    v_mfma_f32_32x32x16_bf16 v[64:79], v[44:47], v[40:43], v[64:79]
    v_mfma_f32_32x32x16_bf16 v[64:79], v[52:55], v[48:51], v[64:79]
    v_mfma_f32_32x32x16_bf16 v[64:79], v[60:63], v[56:59], v[64:79]
    s_waitcnt vmcnt(20) lgkmcnt(0)
    s_barrier
    s_add_u32 m0, s32, 32768
    s_add_u32 s35, s36, 256
    buffer_load_dwordx4 v10, s[20:23], s35 offen lds
    s_add_u32 m0, s32, 33792
    s_add_u32 s35, s36, 22784
    buffer_load_dwordx4 v11, s[20:23], s35 offen lds
    s_add_u32 m0, s32, 40960
    s_add_u32 s35, s37, 131072
    buffer_load_dwordx4 v12, s[44:47], s35 offen lds
    s_add_u32 m0, s32, 41984
    s_add_u32 s35, s37, 139264
    buffer_load_dwordx4 v12, s[44:47], s35 offen lds
    ds_read_b128 v[32:35], v18 offset:0
    ds_read_b64_tr_b16 v[36:37], v22 offset:0
    ds_read_b64_tr_b16 v[38:39], v22 offset:512
    ds_read_b128 v[40:43], v19 offset:0
    ds_read_b64_tr_b16 v[44:45], v22 offset:2048
    ds_read_b64_tr_b16 v[46:47], v22 offset:2560
    ds_read_b128 v[48:51], v20 offset:0
    ds_read_b64_tr_b16 v[52:53], v22 offset:4096
    ds_read_b64_tr_b16 v[54:55], v22 offset:4608
    ds_read_b128 v[56:59], v21 offset:0
    ds_read_b64_tr_b16 v[60:61], v22 offset:6144
    ds_read_b64_tr_b16 v[62:63], v22 offset:6656
    v_mfma_f32_32x32x16_bf16 v[64:79], v[100:103], v[96:99], v[64:79]
    v_mfma_f32_32x32x16_bf16 v[64:79], v[108:111], v[104:107], v[64:79]
    v_mfma_f32_32x32x16_bf16 v[64:79], v[116:119], v[112:115], v[64:79]
    v_mfma_f32_32x32x16_bf16 v[64:79], v[124:127], v[120:123], v[64:79]
    s_waitcnt vmcnt(20) lgkmcnt(0)
    s_barrier
    s_add_u32 m0, s32, 49152
    s_add_u32 s35, s36, 384
    buffer_load_dwordx4 v10, s[20:23], s35 offen lds
    s_add_u32 m0, s32, 50176
    s_add_u32 s35, s36, 22912
    buffer_load_dwordx4 v11, s[20:23], s35 offen lds
    s_add_u32 m0, s32, 57344
    s_add_u32 s35, s37, 196608
    buffer_load_dwordx4 v12, s[44:47], s35 offen lds
    s_add_u32 m0, s32, 58368
    s_add_u32 s35, s37, 204800
    buffer_load_dwordx4 v12, s[44:47], s35 offen lds
    ds_read_b128 v[96:99], v18 offset:16384
    ds_read_b64_tr_b16 v[100:101], v22 offset:16384
    ds_read_b64_tr_b16 v[102:103], v22 offset:16896
    ds_read_b128 v[104:107], v19 offset:16384
    ds_read_b64_tr_b16 v[108:109], v22 offset:18432
    ds_read_b64_tr_b16 v[110:111], v22 offset:18944
    ds_read_b128 v[112:115], v20 offset:16384
    ds_read_b64_tr_b16 v[116:117], v22 offset:20480
    ds_read_b64_tr_b16 v[118:119], v22 offset:20992
    ds_read_b128 v[120:123], v21 offset:16384
    ds_read_b64_tr_b16 v[124:125], v22 offset:22528
    ds_read_b64_tr_b16 v[126:127], v22 offset:23040
    v_mfma_f32_32x32x16_bf16 v[64:79], v[36:39], v[32:35], v[64:79]
    v_mfma_f32_32x32x16_bf16 v[64:79], v[44:47], v[40:43], v[64:79]
    v_mfma_f32_32x32x16_bf16 v[64:79], v[52:55], v[48:51], v[64:79]
    v_mfma_f32_32x32x16_bf16 v[64:79], v[60:63], v[56:59], v[64:79]
    s_waitcnt vmcnt(20) lgkmcnt(0)
    s_barrier
    s_add_u32 m0, s32, 65536
    s_add_u32 s35, s36, 512
    buffer_load_dwordx4 v10, s[20:23], s35 offen lds
    s_add_u32 m0, s32, 66560
    s_add_u32 s35, s36, 23040
    buffer_load_dwordx4 v11, s[20:23], s35 offen lds
    s_add_u32 m0, s32, 73728
    s_add_u32 s35, s37, 262144
    buffer_load_dwordx4 v12, s[44:47], s35 offen lds
    s_add_u32 m0, s32, 74752
    s_add_u32 s35, s37, 270336
    buffer_load_dwordx4 v12, s[44:47], s35 offen lds
    ds_read_b128 v[32:35], v18 offset:32768
    ds_read_b64_tr_b16 v[36:37], v22 offset:32768
    ds_read_b64_tr_b16 v[38:39], v22 offset:33280
    ds_read_b128 v[40:43], v19 offset:32768
    ds_read_b64_tr_b16 v[44:45], v22 offset:34816
    ds_read_b64_tr_b16 v[46:47], v22 offset:35328
    ds_read_b128 v[48:51], v20 offset:32768
    ds_read_b64_tr_b16 v[52:53], v22 offset:36864
    ds_read_b64_tr_b16 v[54:55], v22 offset:37376
    ds_read_b128 v[56:59], v21 offset:32768
    ds_read_b64_tr_b16 v[60:61], v22 offset:38912
    ds_read_b64_tr_b16 v[62:63], v22 offset:39424
    v_mfma_f32_32x32x16_bf16 v[64:79], v[100:103], v[96:99], v[64:79]
    v_mfma_f32_32x32x16_bf16 v[64:79], v[108:111], v[104:107], v[64:79]
    v_mfma_f32_32x32x16_bf16 v[64:79], v[116:119], v[112:115], v[64:79]
    v_mfma_f32_32x32x16_bf16 v[64:79], v[124:127], v[120:123], v[64:79]
    s_waitcnt vmcnt(20) lgkmcnt(0)
    s_barrier
    s_add_u32 m0, s32, 81920
    s_add_u32 s35, s36, 640
    buffer_load_dwordx4 v10, s[20:23], s35 offen lds
    s_add_u32 m0, s32, 82944
    s_add_u32 s35, s36, 23168
    buffer_load_dwordx4 v11, s[20:23], s35 offen lds
    s_add_u32 m0, s32, 90112
    s_add_u32 s35, s37, 327680
    buffer_load_dwordx4 v12, s[44:47], s35 offen lds
    s_add_u32 m0, s32, 91136
    s_add_u32 s35, s37, 335872
    buffer_load_dwordx4 v12, s[44:47], s35 offen lds
    ds_read_b128 v[96:99], v18 offset:49152
    ds_read_b64_tr_b16 v[100:101], v22 offset:49152
    ds_read_b64_tr_b16 v[102:103], v22 offset:49664
    ds_read_b128 v[104:107], v19 offset:49152
    ds_read_b64_tr_b16 v[108:109], v22 offset:51200
    ds_read_b64_tr_b16 v[110:111], v22 offset:51712
    ds_read_b128 v[112:115], v20 offset:49152
    ds_read_b64_tr_b16 v[116:117], v22 offset:53248
    ds_read_b64_tr_b16 v[118:119], v22 offset:53760
    ds_read_b128 v[120:123], v21 offset:49152
    ds_read_b64_tr_b16 v[124:125], v22 offset:55296
    ds_read_b64_tr_b16 v[126:127], v22 offset:55808
    v_mfma_f32_32x32x16_bf16 v[64:79], v[36:39], v[32:35], v[64:79]
    v_mfma_f32_32x32x16_bf16 v[64:79], v[44:47], v[40:43], v[64:79]
    v_mfma_f32_32x32x16_bf16 v[64:79], v[52:55], v[48:51], v[64:79]
    v_mfma_f32_32x32x16_bf16 v[64:79], v[60:63], v[56:59], v[64:79]
    s_waitcnt vmcnt(20) lgkmcnt(0)
    s_barrier
    s_add_u32 m0, s32, 98304
    s_add_u32 s35, s36, 768
    buffer_load_dwordx4 v10, s[20:23], s35 offen lds
    s_add_u32 m0, s32, 99328
    s_add_u32 s35, s36, 23296
    buffer_load_dwordx4 v11, s[20:23], s35 offen lds
    s_add_u32 m0, s32, 106496
    s_add_u32 s35, s37, 393216
    buffer_load_dwordx4 v12, s[44:47], s35 offen lds
    s_add_u32 m0, s32, 107520
    s_add_u32 s35, s37, 401408
    buffer_load_dwordx4 v12, s[44:47], s35 offen lds
    ds_read_b128 v[32:35], v13 offset:0
    ds_read_b64_tr_b16 v[36:37], v17 offset:0
    ds_read_b64_tr_b16 v[38:39], v17 offset:512
    ds_read_b128 v[40:43], v14 offset:0
    ds_read_b64_tr_b16 v[44:45], v17 offset:2048
    ds_read_b64_tr_b16 v[46:47], v17 offset:2560
    ds_read_b128 v[48:51], v15 offset:0
    ds_read_b64_tr_b16 v[52:53], v17 offset:4096
    ds_read_b64_tr_b16 v[54:55], v17 offset:4608
    ds_read_b128 v[56:59], v16 offset:0
    ds_read_b64_tr_b16 v[60:61], v17 offset:6144
    ds_read_b64_tr_b16 v[62:63], v17 offset:6656
    v_mfma_f32_32x32x16_bf16 v[64:79], v[100:103], v[96:99], v[64:79]
    v_mfma_f32_32x32x16_bf16 v[64:79], v[108:111], v[104:107], v[64:79]
    v_mfma_f32_32x32x16_bf16 v[64:79], v[116:119], v[112:115], v[64:79]
    v_mfma_f32_32x32x16_bf16 v[64:79], v[124:127], v[120:123], v[64:79]
    s_waitcnt vmcnt(20) lgkmcnt(0)
    s_barrier
    s_add_u32 m0, s32, 114688
    s_add_u32 s35, s36, 896
    buffer_load_dwordx4 v10, s[20:23], s35 offen lds
    s_add_u32 m0, s32, 115712
    s_add_u32 s35, s36, 23424
    buffer_load_dwordx4 v11, s[20:23], s35 offen lds
    s_add_u32 m0, s32, 122880
    s_add_u32 s35, s37, 458752
    buffer_load_dwordx4 v12, s[44:47], s35 offen lds
    s_add_u32 m0, s32, 123904
    s_add_u32 s35, s37, 466944
    buffer_load_dwordx4 v12, s[44:47], s35 offen lds
    ds_read_b128 v[96:99], v13 offset:16384
    ds_read_b64_tr_b16 v[100:101], v17 offset:16384
    ds_read_b64_tr_b16 v[102:103], v17 offset:16896
    ds_read_b128 v[104:107], v14 offset:16384
    ds_read_b64_tr_b16 v[108:109], v17 offset:18432
    ds_read_b64_tr_b16 v[110:111], v17 offset:18944
    ds_read_b128 v[112:115], v15 offset:16384
    ds_read_b64_tr_b16 v[116:117], v17 offset:20480
    ds_read_b64_tr_b16 v[118:119], v17 offset:20992
    ds_read_b128 v[120:123], v16 offset:16384
    ds_read_b64_tr_b16 v[124:125], v17 offset:22528
    ds_read_b64_tr_b16 v[126:127], v17 offset:23040
    v_mfma_f32_32x32x16_bf16 v[80:95], v[36:39], v[32:35], v[80:95]
    v_mfma_f32_32x32x16_bf16 v[80:95], v[44:47], v[40:43], v[80:95]
    v_mfma_f32_32x32x16_bf16 v[80:95], v[52:55], v[48:51], v[80:95]
    v_mfma_f32_32x32x16_bf16 v[80:95], v[60:63], v[56:59], v[80:95]
    s_waitcnt vmcnt(20) lgkmcnt(0)
    s_barrier
    s_add_u32 m0, s32, 0
    s_add_u32 s35, s36, 1024
    buffer_load_dwordx4 v10, s[20:23], s35 offen lds
    s_add_u32 m0, s32, 1024
    s_add_u32 s35, s36, 23552
    buffer_load_dwordx4 v11, s[20:23], s35 offen lds
    s_add_u32 m0, s32, 8192
    s_add_u32 s35, s37, 524288
    buffer_load_dwordx4 v12, s[44:47], s35 offen lds
    s_add_u32 m0, s32, 9216
    s_add_u32 s35, s37, 532480
    buffer_load_dwordx4 v12, s[44:47], s35 offen lds
    ds_read_b128 v[32:35], v13 offset:32768
    ds_read_b64_tr_b16 v[36:37], v17 offset:32768
    ds_read_b64_tr_b16 v[38:39], v17 offset:33280
    ds_read_b128 v[40:43], v14 offset:32768
    ds_read_b64_tr_b16 v[44:45], v17 offset:34816
    ds_read_b64_tr_b16 v[46:47], v17 offset:35328
    ds_read_b128 v[48:51], v15 offset:32768
    ds_read_b64_tr_b16 v[52:53], v17 offset:36864
    ds_read_b64_tr_b16 v[54:55], v17 offset:37376
    ds_read_b128 v[56:59], v16 offset:32768
    ds_read_b64_tr_b16 v[60:61], v17 offset:38912
    ds_read_b64_tr_b16 v[62:63], v17 offset:39424
    v_mfma_f32_32x32x16_bf16 v[80:95], v[100:103], v[96:99], v[80:95]
    v_mfma_f32_32x32x16_bf16 v[80:95], v[108:111], v[104:107], v[80:95]
    v_mfma_f32_32x32x16_bf16 v[80:95], v[116:119], v[112:115], v[80:95]
    v_mfma_f32_32x32x16_bf16 v[80:95], v[124:127], v[120:123], v[80:95]
    s_waitcnt vmcnt(20) lgkmcnt(0)
    s_barrier
    s_add_u32 m0, s32, 16384
    s_add_u32 s35, s36, 1152
    buffer_load_dwordx4 v10, s[20:23], s35 offen lds
    s_add_u32 m0, s32, 17408
    s_add_u32 s35, s36, 23680
    buffer_load_dwordx4 v11, s[20:23], s35 offen lds
    s_add_u32 m0, s32, 24576
    s_add_u32 s35, s37, 589824
    buffer_load_dwordx4 v12, s[44:47], s35 offen lds
    s_add_u32 m0, s32, 25600
    s_add_u32 s35, s37, 598016
    buffer_load_dwordx4 v12, s[44:47], s35 offen lds
    ds_read_b128 v[96:99], v13 offset:49152
    ds_read_b64_tr_b16 v[100:101], v17 offset:49152
    ds_read_b64_tr_b16 v[102:103], v17 offset:49664
    ds_read_b128 v[104:107], v14 offset:49152
    ds_read_b64_tr_b16 v[108:109], v17 offset:51200
    ds_read_b64_tr_b16 v[110:111], v17 offset:51712
    ds_read_b128 v[112:115], v15 offset:49152
    ds_read_b64_tr_b16 v[116:117], v17 offset:53248
    ds_read_b64_tr_b16 v[118:119], v17 offset:53760
    ds_read_b128 v[120:123], v16 offset:49152
    ds_read_b64_tr_b16 v[124:125], v17 offset:55296
    ds_read_b64_tr_b16 v[126:127], v17 offset:55808
    v_mfma_f32_32x32x16_bf16 v[80:95], v[36:39], v[32:35], v[80:95]
    v_mfma_f32_32x32x16_bf16 v[80:95], v[44:47], v[40:43], v[80:95]
    v_mfma_f32_32x32x16_bf16 v[80:95], v[52:55], v[48:51], v[80:95]
    v_mfma_f32_32x32x16_bf16 v[80:95], v[60:63], v[56:59], v[80:95]
    s_waitcnt vmcnt(20) lgkmcnt(0)
    s_barrier
    s_add_u32 m0, s32, 32768
    s_add_u32 s35, s36, 1280
    buffer_load_dwordx4 v10, s[20:23], s35 offen lds
    s_add_u32 m0, s32, 33792
    s_add_u32 s35, s36, 23808
    buffer_load_dwordx4 v11, s[20:23], s35 offen lds
    s_add_u32 m0, s32, 40960
    s_add_u32 s35, s37, 655360
    buffer_load_dwordx4 v12, s[44:47], s35 offen lds
    s_add_u32 m0, s32, 41984
    s_add_u32 s35, s37, 663552
    buffer_load_dwordx4 v12, s[44:47], s35 offen lds
    ds_read_b128 v[32:35], v18 offset:0
    ds_read_b64_tr_b16 v[36:37], v22 offset:0
    ds_read_b64_tr_b16 v[38:39], v22 offset:512
    ds_read_b128 v[40:43], v19 offset:0
    ds_read_b64_tr_b16 v[44:45], v22 offset:2048
    ds_read_b64_tr_b16 v[46:47], v22 offset:2560
    ds_read_b128 v[48:51], v20 offset:0
    ds_read_b64_tr_b16 v[52:53], v22 offset:4096
    ds_read_b64_tr_b16 v[54:55], v22 offset:4608
    ds_read_b128 v[56:59], v21 offset:0
    ds_read_b64_tr_b16 v[60:61], v22 offset:6144
    ds_read_b64_tr_b16 v[62:63], v22 offset:6656
    v_mfma_f32_32x32x16_bf16 v[80:95], v[100:103], v[96:99], v[80:95]
    v_mfma_f32_32x32x16_bf16 v[80:95], v[108:111], v[104:107], v[80:95]
    v_mfma_f32_32x32x16_bf16 v[80:95], v[116:119], v[112:115], v[80:95]
    v_mfma_f32_32x32x16_bf16 v[80:95], v[124:127], v[120:123], v[80:95]
    s_waitcnt vmcnt(20) lgkmcnt(0)
    s_barrier
    s_add_u32 m0, s32, 49152
    s_add_u32 s35, s36, 1408
    buffer_load_dwordx4 v10, s[20:23], s35 offen lds
    s_add_u32 m0, s32, 50176
    s_add_u32 s35, s36, 23936
    buffer_load_dwordx4 v11, s[20:23], s35 offen lds
    s_add_u32 m0, s32, 57344
    s_add_u32 s35, s37, 720896
    buffer_load_dwordx4 v12, s[44:47], s35 offen lds
    s_add_u32 m0, s32, 58368
    s_add_u32 s35, s37, 729088
    buffer_load_dwordx4 v12, s[44:47], s35 offen lds
    ds_read_b128 v[96:99], v18 offset:16384
    ds_read_b64_tr_b16 v[100:101], v22 offset:16384
    ds_read_b64_tr_b16 v[102:103], v22 offset:16896
    ds_read_b128 v[104:107], v19 offset:16384
    ds_read_b64_tr_b16 v[108:109], v22 offset:18432
    ds_read_b64_tr_b16 v[110:111], v22 offset:18944
    ds_read_b128 v[112:115], v20 offset:16384
    ds_read_b64_tr_b16 v[116:117], v22 offset:20480
    ds_read_b64_tr_b16 v[118:119], v22 offset:20992
    ds_read_b128 v[120:123], v21 offset:16384
    ds_read_b64_tr_b16 v[124:125], v22 offset:22528
    ds_read_b64_tr_b16 v[126:127], v22 offset:23040
    v_mfma_f32_32x32x16_bf16 v[80:95], v[36:39], v[32:35], v[80:95]
    v_mfma_f32_32x32x16_bf16 v[80:95], v[44:47], v[40:43], v[80:95]
    v_mfma_f32_32x32x16_bf16 v[80:95], v[52:55], v[48:51], v[80:95]
    v_mfma_f32_32x32x16_bf16 v[80:95], v[60:63], v[56:59], v[80:95]
    s_waitcnt vmcnt(20) lgkmcnt(0)
    s_barrier
    s_add_u32 m0, s32, 65536
    s_add_u32 s35, s36, 1536
    buffer_load_dwordx4 v10, s[20:23], s35 offen lds
    s_add_u32 m0, s32, 66560
    s_add_u32 s35, s36, 24064
    buffer_load_dwordx4 v11, s[20:23], s35 offen lds
    s_add_u32 m0, s32, 73728
    s_add_u32 s35, s37, 786432
    buffer_load_dwordx4 v12, s[44:47], s35 offen lds
    s_add_u32 m0, s32, 74752
    s_add_u32 s35, s37, 794624
    buffer_load_dwordx4 v12, s[44:47], s35 offen lds
    ds_read_b128 v[32:35], v18 offset:32768
    ds_read_b64_tr_b16 v[36:37], v22 offset:32768
    ds_read_b64_tr_b16 v[38:39], v22 offset:33280
    ds_read_b128 v[40:43], v19 offset:32768
    ds_read_b64_tr_b16 v[44:45], v22 offset:34816
    ds_read_b64_tr_b16 v[46:47], v22 offset:35328
    ds_read_b128 v[48:51], v20 offset:32768
    ds_read_b64_tr_b16 v[52:53], v22 offset:36864
    ds_read_b64_tr_b16 v[54:55], v22 offset:37376
    ds_read_b128 v[56:59], v21 offset:32768
    ds_read_b64_tr_b16 v[60:61], v22 offset:38912
    ds_read_b64_tr_b16 v[62:63], v22 offset:39424
    v_mfma_f32_32x32x16_bf16 v[80:95], v[100:103], v[96:99], v[80:95]
    v_mfma_f32_32x32x16_bf16 v[80:95], v[108:111], v[104:107], v[80:95]
    v_mfma_f32_32x32x16_bf16 v[80:95], v[116:119], v[112:115], v[80:95]
    v_mfma_f32_32x32x16_bf16 v[80:95], v[124:127], v[120:123], v[80:95]
    s_waitcnt vmcnt(20) lgkmcnt(0)
    s_barrier
    s_add_u32 m0, s32, 81920
    s_add_u32 s35, s36, 1664
    buffer_load_dwordx4 v10, s[20:23], s35 offen lds
    s_add_u32 m0, s32, 82944
    s_add_u32 s35, s36, 24192
    buffer_load_dwordx4 v11, s[20:23], s35 offen lds
    s_add_u32 m0, s32, 90112
    s_add_u32 s35, s37, 851968
    buffer_load_dwordx4 v12, s[44:47], s35 offen lds
    s_add_u32 m0, s32, 91136
    s_add_u32 s35, s37, 860160
    buffer_load_dwordx4 v12, s[44:47], s35 offen lds
    ds_read_b128 v[96:99], v18 offset:49152
    ds_read_b64_tr_b16 v[100:101], v22 offset:49152
    ds_read_b64_tr_b16 v[102:103], v22 offset:49664
    ds_read_b128 v[104:107], v19 offset:49152
    ds_read_b64_tr_b16 v[108:109], v22 offset:51200
    ds_read_b64_tr_b16 v[110:111], v22 offset:51712
    ds_read_b128 v[112:115], v20 offset:49152
    ds_read_b64_tr_b16 v[116:117], v22 offset:53248
    ds_read_b64_tr_b16 v[118:119], v22 offset:53760
    ds_read_b128 v[120:123], v21 offset:49152
    ds_read_b64_tr_b16 v[124:125], v22 offset:55296
    ds_read_b64_tr_b16 v[126:127], v22 offset:55808
    v_mfma_f32_32x32x16_bf16 v[80:95], v[36:39], v[32:35], v[80:95]
    v_mfma_f32_32x32x16_bf16 v[80:95], v[44:47], v[40:43], v[80:95]
    v_mfma_f32_32x32x16_bf16 v[80:95], v[52:55], v[48:51], v[80:95]
    v_mfma_f32_32x32x16_bf16 v[80:95], v[60:63], v[56:59], v[80:95]
    s_waitcnt vmcnt(20) lgkmcnt(0)
    s_barrier
    s_add_u32 m0, s32, 98304
    s_add_u32 s35, s36, 1792
    buffer_load_dwordx4 v10, s[20:23], s35 offen lds
    s_add_u32 m0, s32, 99328
    s_add_u32 s35, s36, 24320
    buffer_load_dwordx4 v11, s[20:23], s35 offen lds
    s_add_u32 m0, s32, 106496
    s_add_u32 s35, s37, 917504
    buffer_load_dwordx4 v12, s[44:47], s35 offen lds
    s_add_u32 m0, s32, 107520
    s_add_u32 s35, s37, 925696
    buffer_load_dwordx4 v12, s[44:47], s35 offen lds
    ds_read_b128 v[32:35], v13 offset:0
    ds_read_b64_tr_b16 v[36:37], v17 offset:0
    ds_read_b64_tr_b16 v[38:39], v17 offset:512
    ds_read_b128 v[40:43], v14 offset:0
    ds_read_b64_tr_b16 v[44:45], v17 offset:2048
    ds_read_b64_tr_b16 v[46:47], v17 offset:2560
    ds_read_b128 v[48:51], v15 offset:0
    ds_read_b64_tr_b16 v[52:53], v17 offset:4096
    ds_read_b64_tr_b16 v[54:55], v17 offset:4608
    ds_read_b128 v[56:59], v16 offset:0
    ds_read_b64_tr_b16 v[60:61], v17 offset:6144
    ds_read_b64_tr_b16 v[62:63], v17 offset:6656
    v_mfma_f32_32x32x16_bf16 v[80:95], v[100:103], v[96:99], v[80:95]
    v_mfma_f32_32x32x16_bf16 v[80:95], v[108:111], v[104:107], v[80:95]
    v_mfma_f32_32x32x16_bf16 v[80:95], v[116:119], v[112:115], v[80:95]
    v_mfma_f32_32x32x16_bf16 v[80:95], v[124:127], v[120:123], v[80:95]
    s_waitcnt vmcnt(20) lgkmcnt(0)
    s_barrier
    s_add_u32 m0, s32, 114688
    s_add_u32 s35, s36, 1920
    buffer_load_dwordx4 v10, s[20:23], s35 offen lds
    s_add_u32 m0, s32, 115712
    s_add_u32 s35, s36, 24448
    buffer_load_dwordx4 v11, s[20:23], s35 offen lds
    s_add_u32 m0, s32, 122880
    s_add_u32 s35, s37, 983040
    buffer_load_dwordx4 v12, s[44:47], s35 offen lds
    s_add_u32 m0, s32, 123904
    s_add_u32 s35, s37, 991232
    buffer_load_dwordx4 v12, s[44:47], s35 offen lds
    ds_read_b128 v[96:99], v13 offset:16384
    ds_read_b64_tr_b16 v[100:101], v17 offset:16384
    ds_read_b64_tr_b16 v[102:103], v17 offset:16896
    ds_read_b128 v[104:107], v14 offset:16384
    ds_read_b64_tr_b16 v[108:109], v17 offset:18432
    ds_read_b64_tr_b16 v[110:111], v17 offset:18944
    ds_read_b128 v[112:115], v15 offset:16384
    ds_read_b64_tr_b16 v[116:117], v17 offset:20480
    ds_read_b64_tr_b16 v[118:119], v17 offset:20992
    ds_read_b128 v[120:123], v16 offset:16384
    ds_read_b64_tr_b16 v[124:125], v17 offset:22528
    ds_read_b64_tr_b16 v[126:127], v17 offset:23040
    v_mfma_f32_32x32x16_bf16 v[80:95], v[36:39], v[32:35], v[80:95]
    v_mfma_f32_32x32x16_bf16 v[80:95], v[44:47], v[40:43], v[80:95]
    v_mfma_f32_32x32x16_bf16 v[80:95], v[52:55], v[48:51], v[80:95]
    v_mfma_f32_32x32x16_bf16 v[80:95], v[60:63], v[56:59], v[80:95]
    s_waitcnt vmcnt(20) lgkmcnt(0)
    s_barrier
    s_add_u32 m0, s32, 0
    s_add_u32 s35, s36, 2048
    buffer_load_dwordx4 v10, s[20:23], s35 offen lds
    s_add_u32 m0, s32, 1024
    s_add_u32 s35, s36, 24576
    buffer_load_dwordx4 v11, s[20:23], s35 offen lds
    s_add_u32 m0, s32, 8192
    s_add_u32 s35, s37, 1048576
    buffer_load_dwordx4 v12, s[44:47], s35 offen lds
    s_add_u32 m0, s32, 9216
    s_add_u32 s35, s37, 1056768
    buffer_load_dwordx4 v12, s[44:47], s35 offen lds
    ds_read_b128 v[32:35], v13 offset:32768
    ds_read_b64_tr_b16 v[36:37], v17 offset:32768
    ds_read_b64_tr_b16 v[38:39], v17 offset:33280
    ds_read_b128 v[40:43], v14 offset:32768
    ds_read_b64_tr_b16 v[44:45], v17 offset:34816
    ds_read_b64_tr_b16 v[46:47], v17 offset:35328
    ds_read_b128 v[48:51], v15 offset:32768
    ds_read_b64_tr_b16 v[52:53], v17 offset:36864
    ds_read_b64_tr_b16 v[54:55], v17 offset:37376
    ds_read_b128 v[56:59], v16 offset:32768
    ds_read_b64_tr_b16 v[60:61], v17 offset:38912
    ds_read_b64_tr_b16 v[62:63], v17 offset:39424
    v_mfma_f32_32x32x16_bf16 v[80:95], v[100:103], v[96:99], v[80:95]
    v_mfma_f32_32x32x16_bf16 v[80:95], v[108:111], v[104:107], v[80:95]
    v_mfma_f32_32x32x16_bf16 v[80:95], v[116:119], v[112:115], v[80:95]
    v_mfma_f32_32x32x16_bf16 v[80:95], v[124:127], v[120:123], v[80:95]
    s_waitcnt vmcnt(20) lgkmcnt(0)
    s_barrier
    s_add_u32 m0, s32, 16384
    s_add_u32 s35, s36, 2176
    buffer_load_dwordx4 v10, s[20:23], s35 offen lds
    s_add_u32 m0, s32, 17408
    s_add_u32 s35, s36, 24704
    buffer_load_dwordx4 v11, s[20:23], s35 offen lds
    s_add_u32 m0, s32, 24576
    s_add_u32 s35, s37, 1114112
    buffer_load_dwordx4 v12, s[44:47], s35 offen lds
    s_add_u32 m0, s32, 25600
    s_add_u32 s35, s37, 1122304
    buffer_load_dwordx4 v12, s[44:47], s35 offen lds
    ds_read_b128 v[96:99], v13 offset:49152
    ds_read_b64_tr_b16 v[100:101], v17 offset:49152
    ds_read_b64_tr_b16 v[102:103], v17 offset:49664
    ds_read_b128 v[104:107], v14 offset:49152
    ds_read_b64_tr_b16 v[108:109], v17 offset:51200
    ds_read_b64_tr_b16 v[110:111], v17 offset:51712
    ds_read_b128 v[112:115], v15 offset:49152
    ds_read_b64_tr_b16 v[116:117], v17 offset:53248
    ds_read_b64_tr_b16 v[118:119], v17 offset:53760
    ds_read_b128 v[120:123], v16 offset:49152
    ds_read_b64_tr_b16 v[124:125], v17 offset:55296
    ds_read_b64_tr_b16 v[126:127], v17 offset:55808
    v_mfma_f32_32x32x16_bf16 v[80:95], v[36:39], v[32:35], v[80:95]
    v_mfma_f32_32x32x16_bf16 v[80:95], v[44:47], v[40:43], v[80:95]
    v_mfma_f32_32x32x16_bf16 v[80:95], v[52:55], v[48:51], v[80:95]
    v_mfma_f32_32x32x16_bf16 v[80:95], v[60:63], v[56:59], v[80:95]
    s_waitcnt vmcnt(20) lgkmcnt(0)
    s_barrier
    s_add_u32 m0, s32, 32768
    s_add_u32 s35, s36, 2304
    buffer_load_dwordx4 v10, s[20:23], s35 offen lds
    s_add_u32 m0, s32, 33792
    s_add_u32 s35, s36, 24832
    buffer_load_dwordx4 v11, s[20:23], s35 offen lds
    s_add_u32 m0, s32, 40960
    s_add_u32 s35, s37, 1179648
    buffer_load_dwordx4 v12, s[44:47], s35 offen lds
    s_add_u32 m0, s32, 41984
    s_add_u32 s35, s37, 1187840
    buffer_load_dwordx4 v12, s[44:47], s35 offen lds
    ds_read_b128 v[32:35], v18 offset:0
    ds_read_b64_tr_b16 v[36:37], v22 offset:0
    ds_read_b64_tr_b16 v[38:39], v22 offset:512
    ds_read_b128 v[40:43], v19 offset:0
    ds_read_b64_tr_b16 v[44:45], v22 offset:2048
    ds_read_b64_tr_b16 v[46:47], v22 offset:2560
    ds_read_b128 v[48:51], v20 offset:0
    ds_read_b64_tr_b16 v[52:53], v22 offset:4096
    ds_read_b64_tr_b16 v[54:55], v22 offset:4608
    ds_read_b128 v[56:59], v21 offset:0
    ds_read_b64_tr_b16 v[60:61], v22 offset:6144
    ds_read_b64_tr_b16 v[62:63], v22 offset:6656
    v_mfma_f32_32x32x16_bf16 v[80:95], v[100:103], v[96:99], v[80:95]
    v_mfma_f32_32x32x16_bf16 v[80:95], v[108:111], v[104:107], v[80:95]
    v_mfma_f32_32x32x16_bf16 v[80:95], v[116:119], v[112:115], v[80:95]
    v_mfma_f32_32x32x16_bf16 v[80:95], v[124:127], v[120:123], v[80:95]
    s_waitcnt vmcnt(20) lgkmcnt(0)
    s_barrier
    s_add_u32 m0, s32, 49152
    s_add_u32 s35, s36, 2432
    buffer_load_dwordx4 v10, s[20:23], s35 offen lds
    s_add_u32 m0, s32, 50176
    s_add_u32 s35, s36, 24960
    buffer_load_dwordx4 v11, s[20:23], s35 offen lds
    s_add_u32 m0, s32, 57344
    s_add_u32 s35, s37, 1245184
    buffer_load_dwordx4 v12, s[44:47], s35 offen lds
    s_add_u32 m0, s32, 58368
    s_add_u32 s35, s37, 1253376
    buffer_load_dwordx4 v12, s[44:47], s35 offen lds
    ds_read_b128 v[96:99], v18 offset:16384
    ds_read_b64_tr_b16 v[100:101], v22 offset:16384
    ds_read_b64_tr_b16 v[102:103], v22 offset:16896
    ds_read_b128 v[104:107], v19 offset:16384
    ds_read_b64_tr_b16 v[108:109], v22 offset:18432
    ds_read_b64_tr_b16 v[110:111], v22 offset:18944
    ds_read_b128 v[112:115], v20 offset:16384
    ds_read_b64_tr_b16 v[116:117], v22 offset:20480
    ds_read_b64_tr_b16 v[118:119], v22 offset:20992
    ds_read_b128 v[120:123], v21 offset:16384
    ds_read_b64_tr_b16 v[124:125], v22 offset:22528
    ds_read_b64_tr_b16 v[126:127], v22 offset:23040
    v_mfma_f32_32x32x16_bf16 v[80:95], v[36:39], v[32:35], v[80:95]
    v_mfma_f32_32x32x16_bf16 v[80:95], v[44:47], v[40:43], v[80:95]
    v_mfma_f32_32x32x16_bf16 v[80:95], v[52:55], v[48:51], v[80:95]
    v_mfma_f32_32x32x16_bf16 v[80:95], v[60:63], v[56:59], v[80:95]
    s_waitcnt vmcnt(20) lgkmcnt(0)
    s_barrier
    s_add_u32 m0, s32, 65536
    s_add_u32 s35, s36, 2560
    buffer_load_dwordx4 v10, s[20:23], s35 offen lds
    s_add_u32 m0, s32, 66560
    s_add_u32 s35, s36, 25088
    buffer_load_dwordx4 v11, s[20:23], s35 offen lds
    s_add_u32 m0, s32, 73728
    s_add_u32 s35, s37, 1310720
    buffer_load_dwordx4 v12, s[44:47], s35 offen lds
    s_add_u32 m0, s32, 74752
    s_add_u32 s35, s37, 1318912
    buffer_load_dwordx4 v12, s[44:47], s35 offen lds
    ds_read_b128 v[32:35], v18 offset:32768
    ds_read_b64_tr_b16 v[36:37], v22 offset:32768
    ds_read_b64_tr_b16 v[38:39], v22 offset:33280
    ds_read_b128 v[40:43], v19 offset:32768
    ds_read_b64_tr_b16 v[44:45], v22 offset:34816
    ds_read_b64_tr_b16 v[46:47], v22 offset:35328
    ds_read_b128 v[48:51], v20 offset:32768
    ds_read_b64_tr_b16 v[52:53], v22 offset:36864
    ds_read_b64_tr_b16 v[54:55], v22 offset:37376
    ds_read_b128 v[56:59], v21 offset:32768
    ds_read_b64_tr_b16 v[60:61], v22 offset:38912
    ds_read_b64_tr_b16 v[62:63], v22 offset:39424
    v_mfma_f32_32x32x16_bf16 v[80:95], v[100:103], v[96:99], v[80:95]
    v_mfma_f32_32x32x16_bf16 v[80:95], v[108:111], v[104:107], v[80:95]
    v_mfma_f32_32x32x16_bf16 v[80:95], v[116:119], v[112:115], v[80:95]
    v_mfma_f32_32x32x16_bf16 v[80:95], v[124:127], v[120:123], v[80:95]
    s_waitcnt vmcnt(20) lgkmcnt(0)
    s_barrier
    s_add_u32 m0, s32, 81920
    s_add_u32 s35, s36, 2688
    buffer_load_dwordx4 v10, s[20:23], s35 offen lds
    s_add_u32 m0, s32, 82944
    s_add_u32 s35, s36, 25216
    buffer_load_dwordx4 v11, s[20:23], s35 offen lds
    s_add_u32 m0, s32, 90112
    s_add_u32 s35, s37, 1376256
    buffer_load_dwordx4 v12, s[44:47], s35 offen lds
    s_add_u32 m0, s32, 91136
    s_add_u32 s35, s37, 1384448
    buffer_load_dwordx4 v12, s[44:47], s35 offen lds
    ds_read_b128 v[96:99], v18 offset:49152
    ds_read_b64_tr_b16 v[100:101], v22 offset:49152
    ds_read_b64_tr_b16 v[102:103], v22 offset:49664
    ds_read_b128 v[104:107], v19 offset:49152
    ds_read_b64_tr_b16 v[108:109], v22 offset:51200
    ds_read_b64_tr_b16 v[110:111], v22 offset:51712
    ds_read_b128 v[112:115], v20 offset:49152
    ds_read_b64_tr_b16 v[116:117], v22 offset:53248
    ds_read_b64_tr_b16 v[118:119], v22 offset:53760
    ds_read_b128 v[120:123], v21 offset:49152
    ds_read_b64_tr_b16 v[124:125], v22 offset:55296
    ds_read_b64_tr_b16 v[126:127], v22 offset:55808
    v_mfma_f32_32x32x16_bf16 v[80:95], v[36:39], v[32:35], v[80:95]
    v_mfma_f32_32x32x16_bf16 v[80:95], v[44:47], v[40:43], v[80:95]
    v_mfma_f32_32x32x16_bf16 v[80:95], v[52:55], v[48:51], v[80:95]
    v_mfma_f32_32x32x16_bf16 v[80:95], v[60:63], v[56:59], v[80:95]
    s_waitcnt vmcnt(20) lgkmcnt(0)
    s_barrier
    ds_read_b128 v[32:35], v13 offset:0
    ds_read_b64_tr_b16 v[36:37], v17 offset:0
    ds_read_b64_tr_b16 v[38:39], v17 offset:512
    ds_read_b128 v[40:43], v14 offset:0
    ds_read_b64_tr_b16 v[44:45], v17 offset:2048
    ds_read_b64_tr_b16 v[46:47], v17 offset:2560
    ds_read_b128 v[48:51], v15 offset:0
    ds_read_b64_tr_b16 v[52:53], v17 offset:4096
    ds_read_b64_tr_b16 v[54:55], v17 offset:4608
    ds_read_b128 v[56:59], v16 offset:0
    ds_read_b64_tr_b16 v[60:61], v17 offset:6144
    ds_read_b64_tr_b16 v[62:63], v17 offset:6656
    v_mfma_f32_32x32x16_bf16 v[80:95], v[100:103], v[96:99], v[80:95]
    v_mfma_f32_32x32x16_bf16 v[80:95], v[108:111], v[104:107], v[80:95]
    v_mfma_f32_32x32x16_bf16 v[80:95], v[116:119], v[112:115], v[80:95]
    v_mfma_f32_32x32x16_bf16 v[80:95], v[124:127], v[120:123], v[80:95]
    s_waitcnt vmcnt(16) lgkmcnt(0)
    s_barrier
    ds_read_b128 v[96:99], v13 offset:16384
    ds_read_b64_tr_b16 v[100:101], v17 offset:16384
    ds_read_b64_tr_b16 v[102:103], v17 offset:16896
    ds_read_b128 v[104:107], v14 offset:16384
    ds_read_b64_tr_b16 v[108:109], v17 offset:18432
    ds_read_b64_tr_b16 v[110:111], v17 offset:18944
    ds_read_b128 v[112:115], v15 offset:16384
    ds_read_b64_tr_b16 v[116:117], v17 offset:20480
    ds_read_b64_tr_b16 v[118:119], v17 offset:20992
    ds_read_b128 v[120:123], v16 offset:16384
    ds_read_b64_tr_b16 v[124:125], v17 offset:22528
    ds_read_b64_tr_b16 v[126:127], v17 offset:23040
    v_mfma_f32_32x32x16_bf16 v[80:95], v[36:39], v[32:35], v[80:95]
    v_mfma_f32_32x32x16_bf16 v[80:95], v[44:47], v[40:43], v[80:95]
    v_mfma_f32_32x32x16_bf16 v[80:95], v[52:55], v[48:51], v[80:95]
    v_mfma_f32_32x32x16_bf16 v[80:95], v[60:63], v[56:59], v[80:95]
    s_waitcnt vmcnt(12) lgkmcnt(0)
    s_barrier
    ds_read_b128 v[32:35], v13 offset:32768
    ds_read_b64_tr_b16 v[36:37], v17 offset:32768
    ds_read_b64_tr_b16 v[38:39], v17 offset:33280
    ds_read_b128 v[40:43], v14 offset:32768
    ds_read_b64_tr_b16 v[44:45], v17 offset:34816
    ds_read_b64_tr_b16 v[46:47], v17 offset:35328
    ds_read_b128 v[48:51], v15 offset:32768
    ds_read_b64_tr_b16 v[52:53], v17 offset:36864
    ds_read_b64_tr_b16 v[54:55], v17 offset:37376
    ds_read_b128 v[56:59], v16 offset:32768
    ds_read_b64_tr_b16 v[60:61], v17 offset:38912
    ds_read_b64_tr_b16 v[62:63], v17 offset:39424
    v_mfma_f32_32x32x16_bf16 v[80:95], v[100:103], v[96:99], v[80:95]
    v_mfma_f32_32x32x16_bf16 v[80:95], v[108:111], v[104:107], v[80:95]
    v_mfma_f32_32x32x16_bf16 v[80:95], v[116:119], v[112:115], v[80:95]
    v_mfma_f32_32x32x16_bf16 v[80:95], v[124:127], v[120:123], v[80:95]
    s_waitcnt vmcnt(8) lgkmcnt(0)
    s_barrier
    ds_read_b128 v[96:99], v13 offset:49152
    ds_read_b64_tr_b16 v[100:101], v17 offset:49152
    ds_read_b64_tr_b16 v[102:103], v17 offset:49664
    ds_read_b128 v[104:107], v14 offset:49152
    ds_read_b64_tr_b16 v[108:109], v17 offset:51200
    ds_read_b64_tr_b16 v[110:111], v17 offset:51712
    ds_read_b128 v[112:115], v15 offset:49152
    ds_read_b64_tr_b16 v[116:117], v17 offset:53248
    ds_read_b64_tr_b16 v[118:119], v17 offset:53760
    ds_read_b128 v[120:123], v16 offset:49152
    ds_read_b64_tr_b16 v[124:125], v17 offset:55296
    ds_read_b64_tr_b16 v[126:127], v17 offset:55808
    v_mfma_f32_32x32x16_bf16 v[80:95], v[36:39], v[32:35], v[80:95]
    v_mfma_f32_32x32x16_bf16 v[80:95], v[44:47], v[40:43], v[80:95]
    v_mfma_f32_32x32x16_bf16 v[80:95], v[52:55], v[48:51], v[80:95]
    v_mfma_f32_32x32x16_bf16 v[80:95], v[60:63], v[56:59], v[80:95]
    s_waitcnt vmcnt(4) lgkmcnt(0)
    s_barrier
    ds_read_b128 v[32:35], v18 offset:0
    ds_read_b64_tr_b16 v[36:37], v22 offset:0
    ds_read_b64_tr_b16 v[38:39], v22 offset:512
    ds_read_b128 v[40:43], v19 offset:0
    ds_read_b64_tr_b16 v[44:45], v22 offset:2048
    ds_read_b64_tr_b16 v[46:47], v22 offset:2560
    ds_read_b128 v[48:51], v20 offset:0
    ds_read_b64_tr_b16 v[52:53], v22 offset:4096
    ds_read_b64_tr_b16 v[54:55], v22 offset:4608
    ds_read_b128 v[56:59], v21 offset:0
    ds_read_b64_tr_b16 v[60:61], v22 offset:6144
    ds_read_b64_tr_b16 v[62:63], v22 offset:6656
    v_mfma_f32_32x32x16_bf16 v[80:95], v[100:103], v[96:99], v[80:95]
    v_mfma_f32_32x32x16_bf16 v[80:95], v[108:111], v[104:107], v[80:95]
    v_mfma_f32_32x32x16_bf16 v[80:95], v[116:119], v[112:115], v[80:95]
    v_mfma_f32_32x32x16_bf16 v[80:95], v[124:127], v[120:123], v[80:95]
    s_waitcnt vmcnt(0) lgkmcnt(0)
    s_barrier
    ds_read_b128 v[96:99], v18 offset:16384
    ds_read_b64_tr_b16 v[100:101], v22 offset:16384
    ds_read_b64_tr_b16 v[102:103], v22 offset:16896
    ds_read_b128 v[104:107], v19 offset:16384
    ds_read_b64_tr_b16 v[108:109], v22 offset:18432
    ds_read_b64_tr_b16 v[110:111], v22 offset:18944
    ds_read_b128 v[112:115], v20 offset:16384
    ds_read_b64_tr_b16 v[116:117], v22 offset:20480
    ds_read_b64_tr_b16 v[118:119], v22 offset:20992
    ds_read_b128 v[120:123], v21 offset:16384
    ds_read_b64_tr_b16 v[124:125], v22 offset:22528
    ds_read_b64_tr_b16 v[126:127], v22 offset:23040
    v_mfma_f32_32x32x16_bf16 v[80:95], v[36:39], v[32:35], v[80:95]
    v_mfma_f32_32x32x16_bf16 v[80:95], v[44:47], v[40:43], v[80:95]
    v_mfma_f32_32x32x16_bf16 v[80:95], v[52:55], v[48:51], v[80:95]
    v_mfma_f32_32x32x16_bf16 v[80:95], v[60:63], v[56:59], v[80:95]
    s_waitcnt lgkmcnt(0)
    v_mfma_f32_32x32x16_bf16 v[80:95], v[100:103], v[96:99], v[80:95]
    v_mfma_f32_32x32x16_bf16 v[80:95], v[108:111], v[104:107], v[80:95]
    v_mfma_f32_32x32x16_bf16 v[80:95], v[116:119], v[112:115], v[80:95]
    v_mfma_f32_32x32x16_bf16 v[80:95], v[124:127], v[120:123], v[80:95]
    s_nop 15
    s_nop 15
    s_add_u32 s16, s12, 0x800000
    s_addc_u32 s17, s13, 0
    s_mov_b32 s18, 0x2000
    s_mov_b32 s19, 0x00020000
    s_mov_b32 s20, s8
    s_mov_b32 s21, s9
    s_mov_b32 s22, 0x200000
    s_mov_b32 s23, 0x00020000
    v_and_b32 v3, 31, v2
    v_lshrrev_b32 v4, 5, v2
    s_lshl_b32 s35, s28, 6
    s_lshl_b32 s36, s38, 5
    s_add_u32 s35, s35, s36
    v_add_u32 v3, s35, v3
    v_lshlrev_b32 v5, 2, v3
    buffer_load_dword v6, v5, s[16:19], 0 offen
    v_lshlrev_b32 v5, 10, v3
    v_lshl_add_u32 v5, v4, 4, v5
    s_lshl_b32 s35, s29, 7
    s_lshl_b32 s36, s39, 6
    s_add_u32 s35, s35, s36
    s_waitcnt vmcnt(0)
    v_sub_f32 v7, 1.0, v6
    v_mul_f32 v80, v80, v7
    v_fma_f32 v64, v64, v6, v80
    v_mul_f32 v81, v81, v7
    v_fma_f32 v65, v65, v6, v81
    v_mul_f32 v82, v82, v7
    v_fma_f32 v66, v66, v6, v82
    v_mul_f32 v83, v83, v7
    v_fma_f32 v67, v67, v6, v83
    v_mul_f32 v84, v84, v7
    v_fma_f32 v68, v68, v6, v84
    v_mul_f32 v85, v85, v7
    v_fma_f32 v69, v69, v6, v85
    v_mul_f32 v86, v86, v7
    v_fma_f32 v70, v70, v6, v86
    v_mul_f32 v87, v87, v7
    v_fma_f32 v71, v71, v6, v87
    v_mul_f32 v88, v88, v7
    v_fma_f32 v72, v72, v6, v88
    v_mul_f32 v89, v89, v7
    v_fma_f32 v73, v73, v6, v89
    v_mul_f32 v90, v90, v7
    v_fma_f32 v74, v74, v6, v90
    v_mul_f32 v91, v91, v7
    v_fma_f32 v75, v75, v6, v91
    v_mul_f32 v92, v92, v7
    v_fma_f32 v76, v76, v6, v92
    v_mul_f32 v93, v93, v7
    v_fma_f32 v77, v77, v6, v93
    v_mul_f32 v94, v94, v7
    v_fma_f32 v78, v78, v6, v94
    v_mul_f32 v95, v95, v7
    v_fma_f32 v79, v79, v6, v95
    v_cvt_pk_bf16_f32 v32, v64, v65
    v_cvt_pk_bf16_f32 v33, v66, v67
    v_cvt_pk_bf16_f32 v34, v68, v69
    v_cvt_pk_bf16_f32 v35, v70, v71
    v_cvt_pk_bf16_f32 v36, v72, v73
    v_cvt_pk_bf16_f32 v37, v74, v75
    v_cvt_pk_bf16_f32 v38, v76, v77
    v_cvt_pk_bf16_f32 v39, v78, v79
    s_nop 1
    v_permlane32_swap_b32 v32, v34
    v_permlane32_swap_b32 v33, v35
    v_permlane32_swap_b32 v36, v38
    v_permlane32_swap_b32 v37, v39
    buffer_store_dwordx4 v[32:35], v5, s[20:23], s35 offen offset:0
    buffer_store_dwordx4 v[36:39], v5, s[20:23], s35 offen offset:32
K3_DONE:
    s_endpgm
.section .rodata,"a"
.p2align 6
.amdhsa_kernel k1_gemm_kernel
  .amdhsa_next_free_vgpr 160
  .amdhsa_next_free_sgpr 102
  .amdhsa_accum_offset 160
  .amdhsa_group_segment_fixed_size 0
  .amdhsa_kernarg_size 80
  .amdhsa_user_sgpr_count 2
  .amdhsa_user_sgpr_kernarg_segment_ptr 1
  .amdhsa_system_sgpr_workgroup_id_x 1
.end_amdhsa_kernel
.p2align 6
.amdhsa_kernel k2_attn_kernel
  .amdhsa_next_free_vgpr 120
  .amdhsa_next_free_sgpr 102
  .amdhsa_accum_offset 120
  .amdhsa_group_segment_fixed_size 0
  .amdhsa_kernarg_size 80
  .amdhsa_user_sgpr_count 2
  .amdhsa_user_sgpr_kernarg_segment_ptr 1
  .amdhsa_system_sgpr_workgroup_id_x 1
.end_amdhsa_kernel
.p2align 6
.amdhsa_kernel k3_out_kernel
  .amdhsa_next_free_vgpr 128
  .amdhsa_next_free_sgpr 102
  .amdhsa_accum_offset 128
  .amdhsa_group_segment_fixed_size 0
  .amdhsa_kernarg_size 80
  .amdhsa_user_sgpr_count 2
  .amdhsa_user_sgpr_kernarg_segment_ptr 1
  .amdhsa_system_sgpr_workgroup_id_x 1
.end_amdhsa_kernel
```
